```python
import torch

def _softmax(x, axis=-1):
    return torch.softmax(x, dim=axis)

def _gelu(x):
    return torch.nn.functional.gelu(x, approximate='tanh')

def _silu(x):
    return torch.nn.functional.silu(x)

def _sigmoid(x):
    return torch.sigmoid(x)

def _layernorm(x, axis=-1, eps=1e-05):
    m = x.mean(dim=axis, keepdim=True)
    v = x.var(dim=axis, keepdim=True, unbiased=False)
    return (x - m) / torch.sqrt(v + eps)

def _scatter_add(tgt, idx, src, axis=0):
    return tgt.clone().index_add_(axis, idx, src)

def _segment_sum(src, seg, n):
    out = torch.zeros((n,) + src.shape[1:], dtype=src.dtype)
    return out.index_add_(0, seg, src)

def _pad(x, pw):
    flat = tuple((v for pair in reversed(pw) for v in pair))
    return torch.nn.functional.pad(x, flat)
kernel_name = 'adaLN_cond__gqa_block_cached__glu_gated_geglu__decode'

def setup_inputs():

    _w = lambda a: (lambda t: t.to(torch.bfloat16) if t.is_floating_point() else t)(torch.as_tensor(a))

    def _A_setup():
        B, Sq, D = (8, 1, 576)
        Hq, Hkv, Sk, Dh = (32, 16, 8192, 128)
        assert Hq % Hkv == 0, (Hq, Hkv)
        return {'x': _w((lambda *s: torch.randn(*s, dtype=torch.bfloat16) * 0.1)(B, Sq, D)), 'k_cache': _w((lambda *s: torch.randn(*s, dtype=torch.bfloat16) * 0.8)(B, Hkv, Sk, Dh)), 'v_cache': _w((lambda *s: torch.randn(*s, dtype=torch.bfloat16) * 3.2)(B, Hkv, Sk, Dh)), 'wq': _w((lambda *s: torch.randn(*s, dtype=torch.bfloat16) * 0.8)(D, Hq * Dh) * D ** (-0.5)), 'wo': _w((lambda *s: torch.randn(*s, dtype=torch.bfloat16) * 3.2)(Hq * Dh, D) * (Hq * Dh) ** (-0.5))}
    _A_in = _A_setup()

    def _B_setup():
        B, S, Dm, Df = (8, 1, 576, 4608)
        return {'x': _w((lambda *s: torch.randn(*s, dtype=torch.bfloat16) * 0.1)(B, S, Dm)), 'w_gate': _w((lambda *s: torch.randn(*s, dtype=torch.bfloat16) * 3.2)(Dm, Df) * Dm ** (-0.5)), 'w_up': _w((lambda *s: torch.randn(*s, dtype=torch.bfloat16) * 3.2)(Dm, Df) * Dm ** (-0.5)), 'w_down': _w((lambda *s: torch.randn(*s, dtype=torch.bfloat16) * 3.2)(Df, Dm) * Df ** (-0.5))}
    _B_in = _B_setup()
    return {'A_x': _A_in['x'], 'A_k_cache': _A_in['k_cache'], 'A_v_cache': _A_in['v_cache'], 'A_wq': _A_in['wq'], 'A_wo': _A_in['wo'], 'B_x': _B_in['x'], 'B_w_gate': _B_in['w_gate'], 'B_w_up': _B_in['w_up'], 'B_w_down': _B_in['w_down'], 'c': _w((lambda *s: torch.randn(*s, dtype=torch.bfloat16) * 0.4)(8, 576) * 8.0), 'w_mod': _w((lambda *s: torch.randn(*s, dtype=torch.bfloat16) * 0.4)(576, 6 * 576) * 576 ** (-0.5) * 8.0)}

def reference(A_x, A_k_cache, A_v_cache, A_wq, A_wo, B_x, B_w_gate, B_w_up, B_w_down, c, w_mod):

    def _A_ref(x, k_cache, v_cache, wq, wo):
        B, Sq, D = x.shape
        Hq, Dh = (32, 128)
        Hkv = k_cache.shape[1]
        rep = Hq // Hkv
        q = (lambda x, *d: x.permute(*d))((x @ wq).reshape(B, Sq, Hq, Dh), 0, 2, 1, 3)
        k = (lambda x, n, axis: torch.repeat_interleave(x, n, dim=axis))(k_cache, rep, axis=1)
        v = (lambda x, n, axis: torch.repeat_interleave(x, n, dim=axis))(v_cache, rep, axis=1)
        scores = torch.einsum('bhqd,bhkd->bhqk', q, k) * Dh ** (-0.5)
        p = _softmax(scores, axis=-1)
        o = torch.einsum('bhqk,bhkd->bhqd', p, v)
        return (lambda x, *d: x.permute(*d))(o, 0, 2, 1, 3).reshape(B, Sq, Hq * Dh) @ wo

    def _B_ref(x, w_gate, w_up, w_down):
        g = torch.einsum('bsd,df->bsf', x, w_gate)
        u = torch.einsum('bsd,df->bsf', x, w_up)
        h = _gelu(g) * u
        return torch.einsum('bsf,fd->bsd', h, w_down)
    x = A_x
    mod = (_silu(c) @ w_mod).reshape(c.shape[0], 6, 1, -1)
    sa, ca, ga, sb, cb, gb = (mod[:, 0].clone(), mod[:, 1].clone(), mod[:, 2].clone(), mod[:, 3].clone(), mod[:, 4].clone(), mod[:, 5].clone())
    h = _layernorm(x, axis=-1) * (1 + ca) + sa
    x = x + ga * _A_ref(h, A_k_cache, A_v_cache, A_wq, A_wo)
    h = _layernorm(x, axis=-1) * (1 + cb) + sb
    x = x + gb * _B_ref(h, B_w_gate, B_w_up, B_w_down)
    return x
```

```asm
; @launch grid=(256,1,1) block=(512,1,1) lds=150272
.amdgcn_target "amdgcn-amd-amdhsa--gfx950"
.text
.globl adaLN_cond__gqa_block_cached__glu_gated_geglu__decode_kernel
.p2align 8
.type adaLN_cond__gqa_block_cached__glu_gated_geglu__decode_kernel,@function
adaLN_cond__gqa_block_cached__glu_gated_geglu__decode_kernel:
L_start:
    s_cmp_ge_u32 s2, 256
    s_cbranch_scc1 L_end
    s_load_dwordx16 s[16:31], s[0:1], 0
    s_load_dwordx8 s[32:39], s[0:1], 64
    s_load_dwordx4 s[40:43], s[0:1], 96
    v_lshrrev_b32 v2, 6, v0
    v_and_b32 v1, 63, v0
    v_readfirstlane_b32 s3, v2
    s_mov_b32 s60, 0xffff0000
    s_mov_b32 s61, 0x3fb8aa3b
    s_mov_b32 s66, 1000000
    s_and_b32 s12, s2, 7
    s_lshr_b32 s13, s2, 3
    s_and_b32 s67, s13, 1
    s_lshr_b32 s11, s13, 2
    s_bfe_u32 s10, s13, 0x10001
    s_lshl_b32 s62, s12, 1
    s_add_u32 s10, s10, s62
    s_lshl_b32 s62, s11, 4
    s_add_u32 s62, s62, s10
    s_lshl_b32 s79, s62, 21
    s_and_b32 s15, s3, 3
    v_lshrrev_b32 v2, 4, v1
    v_and_b32 v3, 15, v1
    s_bfe_u32 s62, s13, 0x10003
    s_and_b32 s63, s13, 7
    s_lshl_b32 s63, s63, 1
    s_and_b32 s13, s13, 16
    s_or_b32 s13, s13, s62
    s_or_b32 s13, s13, s63
    s_mov_b32 s62, 0xcccccccc
    s_mov_b32 s63, 0x8888888
    s_andn2_b32 s65, s13, 1
    s_lshl_b32 s65, s65, 1
    s_lshr_b64 s[62:63], s[62:63], s65
    s_lshr_b32 s68, s62, 2
    s_or_b32 s68, s68, s62
    s_and_b32 s68, s68, 3
    s_and_b32 s64, s13, 1
    s_lshl_b32 s64, s64, 1
    s_lshr_b32 s99, s62, s64
    s_and_b32 s99, s99, 3
    s_mov_b32 s62, 0x76543210
    s_mov_b32 s63, 0x6543210
    s_lshr_b64 s[62:63], s[62:63], s65
    s_and_b32 s100, s62, 7
    s_lshl_b32 s62, s12, 3
    s_add_u32 s62, s62, s100
    s_lshl_b32 s100, s100, 3
    s_add_u32 s100, s100, s12
    s_cmp_eq_u32 s68, 3
    s_cselect_b32 s100, s62, s100
    s_cmp_lt_u32 s100, 54
    s_cselect_b32 s64, 3, 1
    s_and_b32 s65, s68, s64
    s_cmp_eq_u32 s65, 0
    s_cselect_b32 s99, 0, s99
    s_cselect_b32 s68, 0, s68
    s_mul_i32 s101, s15, 29696
    s_cmp_lt_u32 s3, 4
    s_cbranch_scc1 L_stream
    s_setprio 2
    v_and_b32 v7, 7, v3
    v_lshrrev_b32 v9, 3, v3
    v_mul_u32_u24 v11, 1152, v7
    v_lshrrev_b32 v4, 3, v1
    v_mul_u32_u24 v11, 1152, v4
    v_lshl_add_u32 v4, v7, 3, v11
    s_lshl_b32 s62, s15, 6
    s_movk_i32 s46, 9216
    s_mov_b32 s47, 0x20000
    s_cmp_eq_u32 s99, 3
    s_waitcnt lgkmcnt(0)
    s_cselect_b32 s44, s16, s34
    s_cselect_b32 s45, s17, s35
    s_cmp_eq_u32 s99, 0
    s_cbranch_scc1 L_helper
    buffer_load_dwordx2 v[16:17], v4, s[44:47], s62 offen offset:0
    buffer_load_dwordx2 v[20:21], v4, s[44:47], s62 offen offset:256
    buffer_load_dwordx2 v[24:25], v4, s[44:47], s62 offen offset:512
    buffer_load_dwordx2 v[28:29], v4, s[44:47], s62 offen offset:768
    buffer_load_dwordx2 v[32:33], v4, s[44:47], s62 offen offset:1024
    buffer_load_ushort v36, v11, s[44:47], 0 offen
    s_branch L_helper
L_stream:
    s_getpc_b64 s[62:63]
    v_lshlrev_b32 v8, 7, v0
    v_min_u32 v8, L_codeend-L_start-512, v8
    s_cmp_lt_u32 s13, 30
    s_cbranch_scc1 L_nocode
    global_load_dword v9, v8, s[62:63]
L_nocode:
    v_lshrrev_b32 v4, 1, v3
    v_lshlrev_b32 v4, 8, v4
    v_lshl_add_u32 v4, v2, 5, v4
    v_and_b32 v5, 1, v3
    v_lshl_add_u32 v4, v5, 4, v4
    s_mov_b32 s76, s15
    s_bitcmp1_b32 s2, 0
    s_cselect_b32 s64, 0x3000, 0
    s_xor_b32 s79, s79, s64
    s_bitcmp1_b32 s2, 1
    s_cselect_b32 s64, 0x18000, 0
    s_xor_b32 s79, s79, s64
    s_bitcmp1_b32 s2, 2
    s_cselect_b32 s64, 0xa000, 0
    s_xor_b32 s79, s79, s64
    s_bitcmp1_b32 s2, 3
    s_cselect_b32 s64, 0x8000, 0
    s_xor_b32 s79, s79, s64
    s_bitcmp1_b32 s2, 4
    s_cselect_b32 s64, 0x4000, 0
    s_xor_b32 s79, s79, s64
    s_bitcmp1_b32 s2, 5
    s_cselect_b32 s64, 0x4000, 0
    s_xor_b32 s79, s79, s64
    s_bitcmp1_b32 s2, 6
    s_cselect_b32 s64, 0x10000, 0
    s_xor_b32 s79, s79, s64
    s_bitcmp1_b32 s2, 7
    s_cselect_b32 s64, 0x9c000, 0
    s_xor_b32 s79, s79, s64
    s_bitcmp1_b32 s76, 0
    s_cselect_b32 s64, 0x6000, 0
    s_xor_b32 s72, s64, s79
    s_bitcmp1_b32 s76, 1
    s_cselect_b32 s64, 0x15000, 0
    s_xor_b32 s72, s64, s72
    s_bitcmp1_b32 s76, 2
    s_cselect_b32 s64, 0x4000, 0
    s_xor_b32 s72, s64, s72
    s_bitcmp1_b32 s76, 3
    s_cselect_b32 s64, 0x98000, 0
    s_xor_b32 s72, s64, s72
    s_bitcmp1_b32 s76, 4
    s_cselect_b32 s64, 0xcc000, 0
    s_xor_b32 s72, s64, s72
    s_bitcmp1_b32 s76, 5
    s_cselect_b32 s64, 0x151000, 0
    s_xor_b32 s72, s64, s72
    s_bitcmp1_b32 s76, 6
    s_cselect_b32 s64, 0x28000, 0
    s_xor_b32 s72, s64, s72
    s_lshr_b32 s70, s76, 7
    s_and_b32 s24, s76, 127
    s_lshl_b32 s24, s24, 7
    s_add_u32 s76, s76, 4
    s_movk_i32 s74, 6912
    s_cmp_eq_u32 s68, 3
    s_cselect_b32 s74, 8192, s74
    v_lshrrev_b32 v10, 3, v1
    v_and_b32 v11, 2, v10
    v_mul_lo_u32 v10, v10, s74
    v_xor_b32 v11, v11, v1
    v_and_b32 v11, 7, v11
    v_lshl_add_u32 v10, v11, 4, v10
    v_xor_b32 v12, 64, v10
    v_add_u32 v11, 192, v0
    v_mul_lo_u32 v11, v11, s74
    s_mul_i32 s75, s74, s15
    s_lshl_b32 s75, s75, 5
    s_lshl_b32 s69, s100, 7
    s_add_u32 s75, s75, s69
    s_mul_i32 s54, s74, 576
    s_mov_b32 s55, 0x20000
    s_mul_i32 s78, s74, 104
    s_lshl_b32 s74, s74, 3
    s_waitcnt lgkmcnt(0)
    s_cmp_eq_u32 s68, 3
    s_cselect_b32 s52, s22, s36
    s_cselect_b32 s53, s23, s37
    s_mov_b32 s44, s18
    s_mov_b32 s45, s19
    s_mov_b32 s46, 268435456
    s_mov_b32 s47, 0x20000
    s_mov_b32 s48, s20
    s_mov_b32 s49, s21
    s_mov_b32 s50, 268435456
    s_mov_b32 s51, 0x20000
    s_cmp_eq_u32 s99, 0
    s_cbranch_scc1 L_notile
    s_add_u32 m0, s101, 0
    s_nop 0
    buffer_load_dwordx4 v10, s[52:55], s75 offen nt lds
    s_add_u32 s75, s75, s74
    s_add_u32 m0, s101, 1024
    s_nop 0
    buffer_load_dwordx4 v12, s[52:55], s75 offen nt lds
    s_add_u32 s75, s75, s74
    s_add_u32 m0, s101, 2048
    s_nop 0
    buffer_load_dwordx4 v10, s[52:55], s75 offen nt lds
    s_add_u32 s75, s75, s74
    s_add_u32 m0, s101, 3072
    s_nop 0
    buffer_load_dwordx4 v12, s[52:55], s75 offen nt lds
    s_add_u32 s75, s75, s78
    s_add_u32 m0, s101, 4096
    s_nop 0
    buffer_load_dwordx4 v10, s[52:55], s75 offen nt lds
    s_add_u32 s75, s75, s74
    s_add_u32 m0, s101, 5120
    s_nop 0
    buffer_load_dwordx4 v12, s[52:55], s75 offen nt lds
    s_add_u32 s75, s75, s74
    s_add_u32 m0, s101, 6144
    s_nop 0
    buffer_load_dwordx4 v10, s[52:55], s75 offen nt lds
    s_add_u32 s75, s75, s74
    s_add_u32 m0, s101, 7168
    s_nop 0
    buffer_load_dwordx4 v12, s[52:55], s75 offen nt lds
    s_add_u32 s75, s75, s78
    s_add_u32 m0, s101, 8192
    s_nop 0
    buffer_load_dwordx4 v10, s[52:55], s75 offen nt lds
    s_add_u32 s75, s75, s74
    s_add_u32 m0, s101, 9216
    s_nop 0
    buffer_load_dwordx4 v12, s[52:55], s75 offen nt lds
    s_add_u32 s75, s75, s74
    s_add_u32 m0, s101, 10240
    s_nop 0
    buffer_load_dwordx4 v10, s[52:55], s75 offen nt lds
    s_add_u32 s75, s75, s74
    s_add_u32 m0, s101, 11264
    s_nop 0
    buffer_load_dwordx4 v12, s[52:55], s75 offen nt lds
    s_add_u32 s75, s75, s78
    s_add_u32 m0, s101, 12288
    s_nop 0
    buffer_load_dwordx4 v10, s[52:55], s75 offen nt lds
    s_add_u32 s75, s75, s74
    s_add_u32 m0, s101, 13312
    s_nop 0
    buffer_load_dwordx4 v12, s[52:55], s75 offen nt lds
    s_add_u32 s75, s75, s74
    s_add_u32 m0, s101, 14336
    s_nop 0
    buffer_load_dwordx4 v10, s[52:55], s75 offen nt lds
    s_add_u32 s75, s75, s74
    s_add_u32 m0, s101, 15360
    s_nop 0
    buffer_load_dwordx4 v12, s[52:55], s75 offen nt lds
    s_add_u32 s75, s75, s78
    s_add_u32 m0, s101, 16384
    s_nop 0
    buffer_load_dwordx4 v10, s[52:55], s75 offen nt lds
    s_add_u32 s75, s75, s74
    s_add_u32 m0, s101, 17408
    s_nop 0
    buffer_load_dwordx4 v12, s[52:55], s75 offen nt lds
    s_add_u32 s75, s75, s74
    s_add_u32 m0, s101, 18432
    s_nop 0
    buffer_load_dwordx4 v10, s[52:55], s75 offen nt lds
    s_add_u32 s75, s75, s74
    s_add_u32 m0, s101, 19456
    s_nop 0
    buffer_load_dwordx4 v12, s[52:55], s75 offen nt lds
    s_cmp_eq_u32 s99, 3
    s_cbranch_scc1 L_hold
    s_cmp_lt_u32 s100, 18
    s_cbranch_scc1 L_hold
    s_mov_b32 s99, 1
    s_branch L_nohold
L_hold:
    s_waitcnt vmcnt(0)
    s_barrier
    s_barrier
    s_barrier
L_nohold:
    buffer_load_dwordx4 v[64:67], v4, s[44:47], s72 offen offset:0 nt
    buffer_load_dwordx4 v[68:71], v4, s[44:47], s72 offen offset:128 nt
    buffer_load_dwordx4 v[72:75], v4, s[44:47], s72 offen offset:2048 nt
    buffer_load_dwordx4 v[76:79], v4, s[44:47], s72 offen offset:2176 nt
    s_xor_b32 s72, s72, 0x10000
    buffer_load_dwordx4 v[80:83], v4, s[44:47], s72 offen offset:0 nt
    buffer_load_dwordx4 v[84:87], v4, s[44:47], s72 offen offset:128 nt
    buffer_load_dwordx4 v[88:91], v4, s[44:47], s72 offen offset:2048 nt
    buffer_load_dwordx4 v[92:95], v4, s[44:47], s72 offen offset:2176 nt
    s_bitcmp1_b32 s76, 0
    s_cselect_b32 s64, 0x6000, 0
    s_xor_b32 s72, s64, s79
    s_bitcmp1_b32 s76, 1
    s_cselect_b32 s64, 0x15000, 0
    s_xor_b32 s72, s64, s72
    s_bitcmp1_b32 s76, 2
    s_cselect_b32 s64, 0x4000, 0
    s_xor_b32 s72, s64, s72
    s_bitcmp1_b32 s76, 3
    s_cselect_b32 s64, 0x98000, 0
    s_xor_b32 s72, s64, s72
    s_bitcmp1_b32 s76, 4
    s_cselect_b32 s64, 0xcc000, 0
    s_xor_b32 s72, s64, s72
    s_bitcmp1_b32 s76, 5
    s_cselect_b32 s64, 0x151000, 0
    s_xor_b32 s72, s64, s72
    s_bitcmp1_b32 s76, 6
    s_cselect_b32 s64, 0x28000, 0
    s_xor_b32 s72, s64, s72
    s_lshr_b32 s70, s76, 7
    s_and_b32 s24, s76, 127
    s_lshl_b32 s24, s24, 7
    s_add_u32 s76, s76, 4
    buffer_load_dwordx4 v[96:99], v4, s[44:47], s72 offen offset:0 nt
    buffer_load_dwordx4 v[100:103], v4, s[44:47], s72 offen offset:128 nt
    buffer_load_dwordx4 v[104:107], v4, s[44:47], s72 offen offset:2048 nt
    buffer_load_dwordx4 v[108:111], v4, s[44:47], s72 offen offset:2176 nt
    s_xor_b32 s72, s72, 0x10000
    buffer_load_dwordx4 v[112:115], v4, s[44:47], s72 offen offset:0 nt
    buffer_load_dwordx4 v[116:119], v4, s[44:47], s72 offen offset:128 nt
    buffer_load_dwordx4 v[120:123], v4, s[44:47], s72 offen offset:2048 nt
    buffer_load_dwordx4 v[124:127], v4, s[44:47], s72 offen offset:2176 nt
    s_branch L_second
L_notile:
    s_cmp_eq_u32 s68, 0
    s_cbranch_scc1 L_nopf
    s_cmp_eq_u32 s68, 3
    s_cbranch_scc1 L_dopf
    s_cmp_ge_u32 s100, 18
    s_cbranch_scc1 L_nopf
L_dopf:
    buffer_load_dword v9, v11, s[52:55], s69 offen
    s_mul_i32 s75, s74, 32
    s_add_u32 s69, s69, s75
    buffer_load_dword v10, v11, s[52:55], s69 offen
L_nopf:
    buffer_load_dwordx4 v[64:67], v4, s[44:47], s72 offen offset:0 nt
    buffer_load_dwordx4 v[68:71], v4, s[44:47], s72 offen offset:128 nt
    buffer_load_dwordx4 v[72:75], v4, s[44:47], s72 offen offset:2048 nt
    buffer_load_dwordx4 v[76:79], v4, s[44:47], s72 offen offset:2176 nt
    s_xor_b32 s72, s72, 0x10000
    buffer_load_dwordx4 v[80:83], v4, s[44:47], s72 offen offset:0 nt
    buffer_load_dwordx4 v[84:87], v4, s[44:47], s72 offen offset:128 nt
    buffer_load_dwordx4 v[88:91], v4, s[44:47], s72 offen offset:2048 nt
    buffer_load_dwordx4 v[92:95], v4, s[44:47], s72 offen offset:2176 nt
    s_bitcmp1_b32 s76, 0
    s_cselect_b32 s64, 0x6000, 0
    s_xor_b32 s72, s64, s79
    s_bitcmp1_b32 s76, 1
    s_cselect_b32 s64, 0x15000, 0
    s_xor_b32 s72, s64, s72
    s_bitcmp1_b32 s76, 2
    s_cselect_b32 s64, 0x4000, 0
    s_xor_b32 s72, s64, s72
    s_bitcmp1_b32 s76, 3
    s_cselect_b32 s64, 0x98000, 0
    s_xor_b32 s72, s64, s72
    s_bitcmp1_b32 s76, 4
    s_cselect_b32 s64, 0xcc000, 0
    s_xor_b32 s72, s64, s72
    s_bitcmp1_b32 s76, 5
    s_cselect_b32 s64, 0x151000, 0
    s_xor_b32 s72, s64, s72
    s_bitcmp1_b32 s76, 6
    s_cselect_b32 s64, 0x28000, 0
    s_xor_b32 s72, s64, s72
    s_lshr_b32 s70, s76, 7
    s_and_b32 s24, s76, 127
    s_lshl_b32 s24, s24, 7
    s_add_u32 s76, s76, 4
    buffer_load_dwordx4 v[96:99], v4, s[44:47], s72 offen offset:0 nt
    buffer_load_dwordx4 v[100:103], v4, s[44:47], s72 offen offset:128 nt
    buffer_load_dwordx4 v[104:107], v4, s[44:47], s72 offen offset:2048 nt
    buffer_load_dwordx4 v[108:111], v4, s[44:47], s72 offen offset:2176 nt
    s_xor_b32 s72, s72, 0x10000
    buffer_load_dwordx4 v[112:115], v4, s[44:47], s72 offen offset:0 nt
    buffer_load_dwordx4 v[116:119], v4, s[44:47], s72 offen offset:128 nt
    buffer_load_dwordx4 v[120:123], v4, s[44:47], s72 offen offset:2048 nt
    buffer_load_dwordx4 v[124:127], v4, s[44:47], s72 offen offset:2176 nt
    s_barrier
L_second:
    s_load_dword s9, s[42:43], 0
    s_mov_b32 s4, s42
    s_mov_b32 s5, s43
    s_mov_b32 s6, 8388608
    s_mov_b32 s7, 0x20000
    v_lshlrev_b32 v30, 3, v5
    v_lshl_add_u32 v30, v2, 4, v30
    v_add_u32 v30, 133888, v30
    v_lshlrev_b32 v31, 8, v5
    v_lshl_add_u32 v31, v2, 5, v31
    v_and_b32 v29, 2, v3
    v_lshl_add_u32 v31, v29, 3, v31
    v_add_u32 v31, 132928, v31
    v_lshlrev_b32 v5, 4, v3
    v_lshl_add_u32 v5, v2, 9, v5
    v_min_u32 v6, 15, v1
    v_lshlrev_b32 v6, 8, v6
    v_mov_b32 v7, 0xff800000
    v_mov_b32 v28, 133440
    v_mov_b32 v29, 1
    s_mov_b32 s69, 0x3db504f3
    s_mov_b32 s26, 0x30003
    s_mov_b32 s27, 0x30003
    s_bitcmp1_b32 s76, 0
    s_cselect_b32 s64, 0x6000, 0
    s_xor_b32 s72, s64, s79
    s_bitcmp1_b32 s76, 1
    s_cselect_b32 s64, 0x15000, 0
    s_xor_b32 s72, s64, s72
    s_bitcmp1_b32 s76, 2
    s_cselect_b32 s64, 0x4000, 0
    s_xor_b32 s72, s64, s72
    s_bitcmp1_b32 s76, 3
    s_cselect_b32 s64, 0x98000, 0
    s_xor_b32 s72, s64, s72
    s_bitcmp1_b32 s76, 4
    s_cselect_b32 s64, 0xcc000, 0
    s_xor_b32 s72, s64, s72
    s_bitcmp1_b32 s76, 5
    s_cselect_b32 s64, 0x151000, 0
    s_xor_b32 s72, s64, s72
    s_bitcmp1_b32 s76, 6
    s_cselect_b32 s64, 0x28000, 0
    s_xor_b32 s72, s64, s72
    s_lshr_b32 s70, s76, 7
    s_and_b32 s24, s76, 127
    s_lshl_b32 s24, s24, 7
    s_add_u32 s76, s76, 4
    buffer_load_dwordx4 v[128:131], v4, s[44:47], s72 offen offset:0 nt
    buffer_load_dwordx4 v[132:135], v4, s[44:47], s72 offen offset:128 nt
    buffer_load_dwordx4 v[136:139], v4, s[44:47], s72 offen offset:2048 nt
    buffer_load_dwordx4 v[140:143], v4, s[44:47], s72 offen offset:2176 nt
    s_xor_b32 s72, s72, 0x10000
    buffer_load_dwordx4 v[144:147], v4, s[44:47], s72 offen offset:0 nt
    buffer_load_dwordx4 v[148:151], v4, s[44:47], s72 offen offset:128 nt
    buffer_load_dwordx4 v[152:155], v4, s[44:47], s72 offen offset:2048 nt
    buffer_load_dwordx4 v[156:159], v4, s[44:47], s72 offen offset:2176 nt
    s_bitcmp1_b32 s76, 0
    s_cselect_b32 s64, 0x6000, 0
    s_xor_b32 s72, s64, s79
    s_bitcmp1_b32 s76, 1
    s_cselect_b32 s64, 0x15000, 0
    s_xor_b32 s72, s64, s72
    s_bitcmp1_b32 s76, 2
    s_cselect_b32 s64, 0x4000, 0
    s_xor_b32 s72, s64, s72
    s_bitcmp1_b32 s76, 3
    s_cselect_b32 s64, 0x98000, 0
    s_xor_b32 s72, s64, s72
    s_bitcmp1_b32 s76, 4
    s_cselect_b32 s64, 0xcc000, 0
    s_xor_b32 s72, s64, s72
    s_bitcmp1_b32 s76, 5
    s_cselect_b32 s64, 0x151000, 0
    s_xor_b32 s72, s64, s72
    s_bitcmp1_b32 s76, 6
    s_cselect_b32 s64, 0x28000, 0
    s_xor_b32 s72, s64, s72
    s_lshr_b32 s70, s76, 7
    s_and_b32 s24, s76, 127
    s_lshl_b32 s24, s24, 7
    s_add_u32 s76, s76, 4
    buffer_load_dwordx4 v[160:163], v4, s[44:47], s72 offen offset:0 nt
    buffer_load_dwordx4 v[164:167], v4, s[44:47], s72 offen offset:128 nt
    buffer_load_dwordx4 v[168:171], v4, s[44:47], s72 offen offset:2048 nt
    buffer_load_dwordx4 v[172:175], v4, s[44:47], s72 offen offset:2176 nt
    s_xor_b32 s72, s72, 0x10000
    buffer_load_dwordx4 v[176:179], v4, s[44:47], s72 offen offset:0 nt
    buffer_load_dwordx4 v[180:183], v4, s[44:47], s72 offen offset:128 nt
    buffer_load_dwordx4 v[184:187], v4, s[44:47], s72 offen offset:2048 nt
    buffer_load_dwordx4 v[188:191], v4, s[44:47], s72 offen offset:2176 nt
    s_bitcmp1_b32 s76, 0
    s_cselect_b32 s64, 0x6000, 0
    s_xor_b32 s72, s64, s79
    s_bitcmp1_b32 s76, 1
    s_cselect_b32 s64, 0x15000, 0
    s_xor_b32 s72, s64, s72
    s_bitcmp1_b32 s76, 2
    s_cselect_b32 s64, 0x4000, 0
    s_xor_b32 s72, s64, s72
    s_bitcmp1_b32 s76, 3
    s_cselect_b32 s64, 0x98000, 0
    s_xor_b32 s72, s64, s72
    s_bitcmp1_b32 s76, 4
    s_cselect_b32 s64, 0xcc000, 0
    s_xor_b32 s72, s64, s72
    s_bitcmp1_b32 s76, 5
    s_cselect_b32 s64, 0x151000, 0
    s_xor_b32 s72, s64, s72
    s_bitcmp1_b32 s76, 6
    s_cselect_b32 s64, 0x28000, 0
    s_xor_b32 s72, s64, s72
    s_lshr_b32 s70, s76, 7
    s_and_b32 s24, s76, 127
    s_lshl_b32 s24, s24, 7
    s_add_u32 s76, s76, 4
    buffer_load_dwordx4 v[192:195], v4, s[44:47], s72 offen offset:0 nt
    buffer_load_dwordx4 v[196:199], v4, s[44:47], s72 offen offset:128 nt
    buffer_load_dwordx4 v[200:203], v4, s[44:47], s72 offen offset:2048 nt
    buffer_load_dwordx4 v[204:207], v4, s[44:47], s72 offen offset:2176 nt
    s_xor_b32 s72, s72, 0x10000
    buffer_load_dwordx4 v[208:211], v4, s[44:47], s72 offen offset:0 nt
    buffer_load_dwordx4 v[212:215], v4, s[44:47], s72 offen offset:128 nt
    buffer_load_dwordx4 v[216:219], v4, s[44:47], s72 offen offset:2048 nt
    buffer_load_dwordx4 v[220:223], v4, s[44:47], s72 offen offset:2176 nt
    s_bitcmp1_b32 s76, 0
    s_cselect_b32 s64, 0x6000, 0
    s_xor_b32 s72, s64, s79
    s_bitcmp1_b32 s76, 1
    s_cselect_b32 s64, 0x15000, 0
    s_xor_b32 s72, s64, s72
    s_bitcmp1_b32 s76, 2
    s_cselect_b32 s64, 0x4000, 0
    s_xor_b32 s72, s64, s72
    s_bitcmp1_b32 s76, 3
    s_cselect_b32 s64, 0x98000, 0
    s_xor_b32 s72, s64, s72
    s_bitcmp1_b32 s76, 4
    s_cselect_b32 s64, 0xcc000, 0
    s_xor_b32 s72, s64, s72
    s_bitcmp1_b32 s76, 5
    s_cselect_b32 s64, 0x151000, 0
    s_xor_b32 s72, s64, s72
    s_bitcmp1_b32 s76, 6
    s_cselect_b32 s64, 0x28000, 0
    s_xor_b32 s72, s64, s72
    s_lshr_b32 s70, s76, 7
    s_and_b32 s24, s76, 127
    s_lshl_b32 s24, s24, 7
    s_add_u32 s76, s76, 4
    buffer_load_dwordx4 v[224:227], v4, s[44:47], s72 offen offset:0 nt
    buffer_load_dwordx4 v[228:231], v4, s[44:47], s72 offen offset:128 nt
    buffer_load_dwordx4 v[232:235], v4, s[44:47], s72 offen offset:2048 nt
    buffer_load_dwordx4 v[236:239], v4, s[44:47], s72 offen offset:2176 nt
    s_xor_b32 s72, s72, 0x10000
    buffer_load_dwordx4 v[240:243], v4, s[44:47], s72 offen offset:0 nt
    buffer_load_dwordx4 v[244:247], v4, s[44:47], s72 offen offset:128 nt
    buffer_load_dwordx4 v[248:251], v4, s[44:47], s72 offen offset:2048 nt
    buffer_load_dwordx4 v[252:255], v4, s[44:47], s72 offen offset:2176 nt
    s_bitcmp1_b32 s76, 0
    s_cselect_b32 s64, 0x6000, 0
    s_xor_b32 s72, s64, s79
    s_bitcmp1_b32 s76, 1
    s_cselect_b32 s64, 0x15000, 0
    s_xor_b32 s72, s64, s72
    s_bitcmp1_b32 s76, 2
    s_cselect_b32 s64, 0x4000, 0
    s_xor_b32 s72, s64, s72
    s_bitcmp1_b32 s76, 3
    s_cselect_b32 s64, 0x98000, 0
    s_xor_b32 s72, s64, s72
    s_bitcmp1_b32 s76, 4
    s_cselect_b32 s64, 0xcc000, 0
    s_xor_b32 s72, s64, s72
    s_bitcmp1_b32 s76, 5
    s_cselect_b32 s64, 0x151000, 0
    s_xor_b32 s72, s64, s72
    s_bitcmp1_b32 s76, 6
    s_cselect_b32 s64, 0x28000, 0
    s_xor_b32 s72, s64, s72
    s_lshr_b32 s70, s76, 7
    s_and_b32 s24, s76, 127
    s_lshl_b32 s24, s24, 7
    s_add_u32 s76, s76, 4
    buffer_load_dwordx4 v[32:35], v4, s[44:47], s72 offen offset:0 nt
    buffer_load_dwordx4 v[36:39], v4, s[44:47], s72 offen offset:128 nt
    buffer_load_dwordx4 v[40:43], v4, s[44:47], s72 offen offset:2048 nt
    buffer_load_dwordx4 v[44:47], v4, s[44:47], s72 offen offset:2176 nt
    s_xor_b32 s72, s72, 0x10000
    buffer_load_dwordx4 v[48:51], v4, s[44:47], s72 offen offset:0 nt
    buffer_load_dwordx4 v[52:55], v4, s[44:47], s72 offen offset:128 nt
    buffer_load_dwordx4 v[56:59], v4, s[44:47], s72 offen offset:2048 nt
    buffer_load_dwordx4 v[60:63], v4, s[44:47], s72 offen offset:2176 nt
    s_cmp_lg_u32 s99, 1
    s_cbranch_scc1 L_nolb
    s_waitcnt vmcnt(56)
    s_barrier
    s_barrier
    s_barrier
L_nolb:
    s_mov_b64 exec, 1
    ds_add_u32 v28, v29 offset:24
    s_mov_b64 exec, -1
    s_waitcnt vmcnt(56) lgkmcnt(0)
    s_add_u32 s9, s9, 0x9e3779b9
    s_and_b32 s8, s9, 0xbfffbfff
    s_cmp_eq_u32 s99, 3
    s_cselect_b32 s30, 88, 0
    s_cmp_eq_u32 s99, 2
    s_cselect_b32 s30, 56, s30
    s_mov_b32 s77, 0x20000000
L_qwait:
    ds_read_b32 v9, v28 offset:4
    ds_read_b128 v[12:15], v31 offset:0
    ds_read_b128 v[16:19], v31 offset:128
    s_waitcnt lgkmcnt(0)
    v_readfirstlane_b32 s62, v9
    s_nop 0
    s_cmp_eq_u32 s62, 1
    s_cbranch_scc1 L_qok
    s_sleep 2
    s_sub_u32 s66, s66, 1
    s_cmp_lg_u32 s66, 0
    s_cbranch_scc1 L_qwait
    s_branch L_exit
L_qok:
    s_lshl_b32 s62, s15, 7
    v_add_u32 v31, s62, v30
    s_waitcnt vmcnt(52)
    v_mfma_f32_16x16x32_bf16 v[20:23], v[64:67], v[12:15], 0
    v_mfma_f32_16x16x32_bf16 v[24:27], v[72:75], v[12:15], 0
    v_mfma_f32_16x16x32_bf16 v[20:23], v[68:71], v[16:19], v[20:23]
    v_mfma_f32_16x16x32_bf16 v[24:27], v[76:79], v[16:19], v[24:27]
    s_bitcmp1_b32 s76, 0
    s_cselect_b32 s64, 0x6000, 0
    s_xor_b32 s72, s64, s79
    s_bitcmp1_b32 s76, 1
    s_cselect_b32 s64, 0x15000, 0
    s_xor_b32 s72, s64, s72
    s_bitcmp1_b32 s76, 2
    s_cselect_b32 s64, 0x4000, 0
    s_xor_b32 s72, s64, s72
    s_bitcmp1_b32 s76, 3
    s_cselect_b32 s64, 0x98000, 0
    s_xor_b32 s72, s64, s72
    s_bitcmp1_b32 s76, 4
    s_cselect_b32 s64, 0xcc000, 0
    s_xor_b32 s72, s64, s72
    s_bitcmp1_b32 s76, 5
    s_cselect_b32 s64, 0x151000, 0
    s_xor_b32 s72, s64, s72
    s_bitcmp1_b32 s76, 6
    s_cselect_b32 s64, 0x28000, 0
    s_xor_b32 s72, s64, s72
    s_lshr_b32 s70, s76, 7
    s_and_b32 s24, s76, 127
    s_lshl_b32 s24, s24, 7
    s_add_u32 s76, s76, 4
    buffer_load_dwordx4 v[64:67], v4, s[44:47], s72 offen offset:0 nt
    buffer_load_dwordx4 v[68:71], v4, s[44:47], s72 offen offset:128 nt
    buffer_load_dwordx4 v[72:75], v4, s[44:47], s72 offen offset:2048 nt
    buffer_load_dwordx4 v[76:79], v4, s[44:47], s72 offen offset:2176 nt
    s_xor_b32 s72, s72, 0x10000
    v_mov_b32_dpp v8, v20 quad_perm:[0,1,0,1] row_mask:0xf bank_mask:0xf
    v_mov_b32_dpp v9, v22 quad_perm:[0,1,0,1] row_mask:0xf bank_mask:0xf
    v_mov_b32_dpp v10, v24 quad_perm:[0,1,0,1] row_mask:0xf bank_mask:0xf
    v_mov_b32_dpp v11, v26 quad_perm:[0,1,0,1] row_mask:0xf bank_mask:0xf
    v_add_f32_dpp v8, v21, v8 quad_perm:[2,3,2,3] row_mask:0xf bank_mask:0xf
    v_add_f32_dpp v9, v23, v9 quad_perm:[2,3,2,3] row_mask:0xf bank_mask:0xf
    v_add_f32_dpp v10, v25, v10 quad_perm:[2,3,2,3] row_mask:0xf bank_mask:0xf
    v_add_f32_dpp v11, v27, v11 quad_perm:[2,3,2,3] row_mask:0xf bank_mask:0xf
    v_cvt_pk_bf16_f32 v28, v8, v9
    v_cvt_pk_bf16_f32 v29, v10, v11
    v_lshlrev_b32 v8, 16, v28
    v_and_b32 v9, s60, v28
    v_lshlrev_b32 v10, 16, v29
    v_and_b32 v11, s60, v29
    v_mul_f32 v8, s69, v8
    v_mul_f32 v9, s69, v9
    v_mul_f32 v10, s69, v10
    v_mul_f32 v11, s69, v11
    v_cvt_pk_bf16_f32 v28, v8, v9
    v_cvt_pk_bf16_f32 v29, v10, v11
    v_lshlrev_b32 v8, 16, v28
    v_and_b32 v9, s60, v28
    v_lshlrev_b32 v10, 16, v29
    v_and_b32 v11, s60, v29
    s_mov_b64 exec, s[26:27]
    ds_write_b64 v31, v[28:29] offset:0
    s_mov_b64 exec, -1
    v_max3_f32 v7, v8, v9, v7
    v_max3_f32 v7, v10, v11, v7
    s_waitcnt vmcnt(52)
    v_mfma_f32_16x16x32_bf16 v[20:23], v[80:83], v[12:15], 0
    v_mfma_f32_16x16x32_bf16 v[24:27], v[88:91], v[12:15], 0
    v_mfma_f32_16x16x32_bf16 v[20:23], v[84:87], v[16:19], v[20:23]
    v_mfma_f32_16x16x32_bf16 v[24:27], v[92:95], v[16:19], v[24:27]
    buffer_load_dwordx4 v[80:83], v4, s[44:47], s72 offen offset:0 nt
    buffer_load_dwordx4 v[84:87], v4, s[44:47], s72 offen offset:128 nt
    buffer_load_dwordx4 v[88:91], v4, s[44:47], s72 offen offset:2048 nt
    buffer_load_dwordx4 v[92:95], v4, s[44:47], s72 offen offset:2176 nt
    s_nop 2
    v_mov_b32_dpp v8, v20 quad_perm:[0,1,0,1] row_mask:0xf bank_mask:0xf
    v_mov_b32_dpp v9, v22 quad_perm:[0,1,0,1] row_mask:0xf bank_mask:0xf
    v_mov_b32_dpp v10, v24 quad_perm:[0,1,0,1] row_mask:0xf bank_mask:0xf
    v_mov_b32_dpp v11, v26 quad_perm:[0,1,0,1] row_mask:0xf bank_mask:0xf
    v_add_f32_dpp v8, v21, v8 quad_perm:[2,3,2,3] row_mask:0xf bank_mask:0xf
    v_add_f32_dpp v9, v23, v9 quad_perm:[2,3,2,3] row_mask:0xf bank_mask:0xf
    v_add_f32_dpp v10, v25, v10 quad_perm:[2,3,2,3] row_mask:0xf bank_mask:0xf
    v_add_f32_dpp v11, v27, v11 quad_perm:[2,3,2,3] row_mask:0xf bank_mask:0xf
    v_cvt_pk_bf16_f32 v28, v8, v9
    v_cvt_pk_bf16_f32 v29, v10, v11
    v_lshlrev_b32 v8, 16, v28
    v_and_b32 v9, s60, v28
    v_lshlrev_b32 v10, 16, v29
    v_and_b32 v11, s60, v29
    v_mul_f32 v8, s69, v8
    v_mul_f32 v9, s69, v9
    v_mul_f32 v10, s69, v10
    v_mul_f32 v11, s69, v11
    v_cvt_pk_bf16_f32 v28, v8, v9
    v_cvt_pk_bf16_f32 v29, v10, v11
    v_lshlrev_b32 v8, 16, v28
    v_and_b32 v9, s60, v28
    v_lshlrev_b32 v10, 16, v29
    v_and_b32 v11, s60, v29
    s_mov_b64 exec, s[26:27]
    ds_write_b64 v31, v[28:29] offset:64
    s_mov_b64 exec, -1
    v_max3_f32 v7, v8, v9, v7
    v_max3_f32 v7, v10, v11, v7
    v_add_u32 v31, 512, v31
    s_waitcnt vmcnt(52)
    v_mfma_f32_16x16x32_bf16 v[20:23], v[96:99], v[12:15], 0
    v_mfma_f32_16x16x32_bf16 v[24:27], v[104:107], v[12:15], 0
    v_mfma_f32_16x16x32_bf16 v[20:23], v[100:103], v[16:19], v[20:23]
    v_mfma_f32_16x16x32_bf16 v[24:27], v[108:111], v[16:19], v[24:27]
    s_bitcmp1_b32 s76, 0
    s_cselect_b32 s64, 0x6000, 0
    s_xor_b32 s73, s64, s79
    s_bitcmp1_b32 s76, 1
    s_cselect_b32 s64, 0x15000, 0
    s_xor_b32 s73, s64, s73
    s_bitcmp1_b32 s76, 2
    s_cselect_b32 s64, 0x4000, 0
    s_xor_b32 s73, s64, s73
    s_bitcmp1_b32 s76, 3
    s_cselect_b32 s64, 0x98000, 0
    s_xor_b32 s73, s64, s73
    s_bitcmp1_b32 s76, 4
    s_cselect_b32 s64, 0xcc000, 0
    s_xor_b32 s73, s64, s73
    s_bitcmp1_b32 s76, 5
    s_cselect_b32 s64, 0x151000, 0
    s_xor_b32 s73, s64, s73
    s_bitcmp1_b32 s76, 6
    s_cselect_b32 s64, 0x28000, 0
    s_xor_b32 s73, s64, s73
    s_lshr_b32 s71, s76, 7
    s_and_b32 s25, s76, 127
    s_lshl_b32 s25, s25, 7
    s_add_u32 s76, s76, 4
    buffer_load_dwordx4 v[96:99], v4, s[44:47], s73 offen offset:0 nt
    buffer_load_dwordx4 v[100:103], v4, s[44:47], s73 offen offset:128 nt
    buffer_load_dwordx4 v[104:107], v4, s[44:47], s73 offen offset:2048 nt
    buffer_load_dwordx4 v[108:111], v4, s[44:47], s73 offen offset:2176 nt
    s_xor_b32 s73, s73, 0x10000
    v_mov_b32_dpp v8, v20 quad_perm:[0,1,0,1] row_mask:0xf bank_mask:0xf
    v_mov_b32_dpp v9, v22 quad_perm:[0,1,0,1] row_mask:0xf bank_mask:0xf
    v_mov_b32_dpp v10, v24 quad_perm:[0,1,0,1] row_mask:0xf bank_mask:0xf
    v_mov_b32_dpp v11, v26 quad_perm:[0,1,0,1] row_mask:0xf bank_mask:0xf
    v_add_f32_dpp v8, v21, v8 quad_perm:[2,3,2,3] row_mask:0xf bank_mask:0xf
    v_add_f32_dpp v9, v23, v9 quad_perm:[2,3,2,3] row_mask:0xf bank_mask:0xf
    v_add_f32_dpp v10, v25, v10 quad_perm:[2,3,2,3] row_mask:0xf bank_mask:0xf
    v_add_f32_dpp v11, v27, v11 quad_perm:[2,3,2,3] row_mask:0xf bank_mask:0xf
    v_cvt_pk_bf16_f32 v28, v8, v9
    v_cvt_pk_bf16_f32 v29, v10, v11
    v_lshlrev_b32 v8, 16, v28
    v_and_b32 v9, s60, v28
    v_lshlrev_b32 v10, 16, v29
    v_and_b32 v11, s60, v29
    v_mul_f32 v8, s69, v8
    v_mul_f32 v9, s69, v9
    v_mul_f32 v10, s69, v10
    v_mul_f32 v11, s69, v11
    v_cvt_pk_bf16_f32 v28, v8, v9
    v_cvt_pk_bf16_f32 v29, v10, v11
    v_lshlrev_b32 v8, 16, v28
    v_and_b32 v9, s60, v28
    v_lshlrev_b32 v10, 16, v29
    v_and_b32 v11, s60, v29
    s_mov_b64 exec, s[26:27]
    ds_write_b64 v31, v[28:29] offset:0
    s_mov_b64 exec, -1
    v_max3_f32 v7, v8, v9, v7
    v_max3_f32 v7, v10, v11, v7
    s_waitcnt vmcnt(52)
    v_mfma_f32_16x16x32_bf16 v[20:23], v[112:115], v[12:15], 0
    v_mfma_f32_16x16x32_bf16 v[24:27], v[120:123], v[12:15], 0
    v_mfma_f32_16x16x32_bf16 v[20:23], v[116:119], v[16:19], v[20:23]
    v_mfma_f32_16x16x32_bf16 v[24:27], v[124:127], v[16:19], v[24:27]
    buffer_load_dwordx4 v[112:115], v4, s[44:47], s73 offen offset:0 nt
    buffer_load_dwordx4 v[116:119], v4, s[44:47], s73 offen offset:128 nt
    buffer_load_dwordx4 v[120:123], v4, s[44:47], s73 offen offset:2048 nt
    buffer_load_dwordx4 v[124:127], v4, s[44:47], s73 offen offset:2176 nt
    s_nop 2
    v_mov_b32_dpp v8, v20 quad_perm:[0,1,0,1] row_mask:0xf bank_mask:0xf
    v_mov_b32_dpp v9, v22 quad_perm:[0,1,0,1] row_mask:0xf bank_mask:0xf
    v_mov_b32_dpp v10, v24 quad_perm:[0,1,0,1] row_mask:0xf bank_mask:0xf
    v_mov_b32_dpp v11, v26 quad_perm:[0,1,0,1] row_mask:0xf bank_mask:0xf
    v_add_f32_dpp v8, v21, v8 quad_perm:[2,3,2,3] row_mask:0xf bank_mask:0xf
    v_add_f32_dpp v9, v23, v9 quad_perm:[2,3,2,3] row_mask:0xf bank_mask:0xf
    v_add_f32_dpp v10, v25, v10 quad_perm:[2,3,2,3] row_mask:0xf bank_mask:0xf
    v_add_f32_dpp v11, v27, v11 quad_perm:[2,3,2,3] row_mask:0xf bank_mask:0xf
    v_cvt_pk_bf16_f32 v28, v8, v9
    v_cvt_pk_bf16_f32 v29, v10, v11
    v_lshlrev_b32 v8, 16, v28
    v_and_b32 v9, s60, v28
    v_lshlrev_b32 v10, 16, v29
    v_and_b32 v11, s60, v29
    v_mul_f32 v8, s69, v8
    v_mul_f32 v9, s69, v9
    v_mul_f32 v10, s69, v10
    v_mul_f32 v11, s69, v11
    v_cvt_pk_bf16_f32 v28, v8, v9
    v_cvt_pk_bf16_f32 v29, v10, v11
    v_lshlrev_b32 v8, 16, v28
    v_and_b32 v9, s60, v28
    v_lshlrev_b32 v10, 16, v29
    v_and_b32 v11, s60, v29
    s_mov_b64 exec, s[26:27]
    ds_write_b64 v31, v[28:29] offset:64
    s_mov_b64 exec, -1
    v_max3_f32 v7, v8, v9, v7
    v_max3_f32 v7, v10, v11, v7
    v_add_u32 v31, 512, v31
    s_waitcnt vmcnt(52)
    v_mfma_f32_16x16x32_bf16 v[20:23], v[128:131], v[12:15], 0
    v_mfma_f32_16x16x32_bf16 v[24:27], v[136:139], v[12:15], 0
    v_mfma_f32_16x16x32_bf16 v[20:23], v[132:135], v[16:19], v[20:23]
    v_mfma_f32_16x16x32_bf16 v[24:27], v[140:143], v[16:19], v[24:27]
    s_nop 6
    v_mov_b32_dpp v8, v20 quad_perm:[0,1,0,1] row_mask:0xf bank_mask:0xf
    v_mov_b32_dpp v9, v22 quad_perm:[0,1,0,1] row_mask:0xf bank_mask:0xf
    v_mov_b32_dpp v10, v24 quad_perm:[0,1,0,1] row_mask:0xf bank_mask:0xf
    v_mov_b32_dpp v11, v26 quad_perm:[0,1,0,1] row_mask:0xf bank_mask:0xf
    v_add_f32_dpp v8, v21, v8 quad_perm:[2,3,2,3] row_mask:0xf bank_mask:0xf
    v_add_f32_dpp v9, v23, v9 quad_perm:[2,3,2,3] row_mask:0xf bank_mask:0xf
    v_add_f32_dpp v10, v25, v10 quad_perm:[2,3,2,3] row_mask:0xf bank_mask:0xf
    v_add_f32_dpp v11, v27, v11 quad_perm:[2,3,2,3] row_mask:0xf bank_mask:0xf
    v_cvt_pk_bf16_f32 v28, v8, v9
    v_cvt_pk_bf16_f32 v29, v10, v11
    v_lshlrev_b32 v8, 16, v28
    v_and_b32 v9, s60, v28
    v_lshlrev_b32 v10, 16, v29
    v_and_b32 v11, s60, v29
    v_mul_f32 v8, s69, v8
    v_mul_f32 v9, s69, v9
    v_mul_f32 v10, s69, v10
    v_mul_f32 v11, s69, v11
    v_cvt_pk_bf16_f32 v28, v8, v9
    v_cvt_pk_bf16_f32 v29, v10, v11
    v_lshlrev_b32 v8, 16, v28
    v_and_b32 v9, s60, v28
    v_lshlrev_b32 v10, 16, v29
    v_and_b32 v11, s60, v29
    s_mov_b64 exec, s[26:27]
    ds_write_b64 v31, v[28:29] offset:0
    s_mov_b64 exec, -1
    v_max3_f32 v7, v8, v9, v7
    v_max3_f32 v7, v10, v11, v7
    s_waitcnt vmcnt(48)
    v_mfma_f32_16x16x32_bf16 v[20:23], v[144:147], v[12:15], 0
    v_mfma_f32_16x16x32_bf16 v[24:27], v[152:155], v[12:15], 0
    v_mfma_f32_16x16x32_bf16 v[20:23], v[148:151], v[16:19], v[20:23]
    v_mfma_f32_16x16x32_bf16 v[24:27], v[156:159], v[16:19], v[24:27]
    s_nop 6
    v_mov_b32_dpp v8, v20 quad_perm:[0,1,0,1] row_mask:0xf bank_mask:0xf
    v_mov_b32_dpp v9, v22 quad_perm:[0,1,0,1] row_mask:0xf bank_mask:0xf
    v_mov_b32_dpp v10, v24 quad_perm:[0,1,0,1] row_mask:0xf bank_mask:0xf
    v_mov_b32_dpp v11, v26 quad_perm:[0,1,0,1] row_mask:0xf bank_mask:0xf
    v_add_f32_dpp v8, v21, v8 quad_perm:[2,3,2,3] row_mask:0xf bank_mask:0xf
    v_add_f32_dpp v9, v23, v9 quad_perm:[2,3,2,3] row_mask:0xf bank_mask:0xf
    v_add_f32_dpp v10, v25, v10 quad_perm:[2,3,2,3] row_mask:0xf bank_mask:0xf
    v_add_f32_dpp v11, v27, v11 quad_perm:[2,3,2,3] row_mask:0xf bank_mask:0xf
    v_cvt_pk_bf16_f32 v28, v8, v9
    v_cvt_pk_bf16_f32 v29, v10, v11
    v_lshlrev_b32 v8, 16, v28
    v_and_b32 v9, s60, v28
    v_lshlrev_b32 v10, 16, v29
    v_and_b32 v11, s60, v29
    v_mul_f32 v8, s69, v8
    v_mul_f32 v9, s69, v9
    v_mul_f32 v10, s69, v10
    v_mul_f32 v11, s69, v11
    v_cvt_pk_bf16_f32 v28, v8, v9
    v_cvt_pk_bf16_f32 v29, v10, v11
    v_lshlrev_b32 v8, 16, v28
    v_and_b32 v9, s60, v28
    v_lshlrev_b32 v10, 16, v29
    v_and_b32 v11, s60, v29
    s_mov_b64 exec, s[26:27]
    ds_write_b64 v31, v[28:29] offset:64
    s_mov_b64 exec, -1
    v_max3_f32 v7, v8, v9, v7
    v_max3_f32 v7, v10, v11, v7
    v_add_u32 v31, 512, v31
    s_waitcnt vmcnt(44)
    v_mfma_f32_16x16x32_bf16 v[20:23], v[160:163], v[12:15], 0
    v_mfma_f32_16x16x32_bf16 v[24:27], v[168:171], v[12:15], 0
    v_mfma_f32_16x16x32_bf16 v[20:23], v[164:167], v[16:19], v[20:23]
    v_mfma_f32_16x16x32_bf16 v[24:27], v[172:175], v[16:19], v[24:27]
    s_nop 6
    v_mov_b32_dpp v8, v20 quad_perm:[0,1,0,1] row_mask:0xf bank_mask:0xf
    v_mov_b32_dpp v9, v22 quad_perm:[0,1,0,1] row_mask:0xf bank_mask:0xf
    v_mov_b32_dpp v10, v24 quad_perm:[0,1,0,1] row_mask:0xf bank_mask:0xf
    v_mov_b32_dpp v11, v26 quad_perm:[0,1,0,1] row_mask:0xf bank_mask:0xf
    v_add_f32_dpp v8, v21, v8 quad_perm:[2,3,2,3] row_mask:0xf bank_mask:0xf
    v_add_f32_dpp v9, v23, v9 quad_perm:[2,3,2,3] row_mask:0xf bank_mask:0xf
    v_add_f32_dpp v10, v25, v10 quad_perm:[2,3,2,3] row_mask:0xf bank_mask:0xf
    v_add_f32_dpp v11, v27, v11 quad_perm:[2,3,2,3] row_mask:0xf bank_mask:0xf
    v_cvt_pk_bf16_f32 v28, v8, v9
    v_cvt_pk_bf16_f32 v29, v10, v11
    v_lshlrev_b32 v8, 16, v28
    v_and_b32 v9, s60, v28
    v_lshlrev_b32 v10, 16, v29
    v_and_b32 v11, s60, v29
    v_mul_f32 v8, s69, v8
    v_mul_f32 v9, s69, v9
    v_mul_f32 v10, s69, v10
    v_mul_f32 v11, s69, v11
    v_cvt_pk_bf16_f32 v28, v8, v9
    v_cvt_pk_bf16_f32 v29, v10, v11
    v_lshlrev_b32 v8, 16, v28
    v_and_b32 v9, s60, v28
    v_lshlrev_b32 v10, 16, v29
    v_and_b32 v11, s60, v29
    s_mov_b64 exec, s[26:27]
    ds_write_b64 v31, v[28:29] offset:0
    s_mov_b64 exec, -1
    v_max3_f32 v7, v8, v9, v7
    v_max3_f32 v7, v10, v11, v7
    s_waitcnt vmcnt(40)
    v_mfma_f32_16x16x32_bf16 v[20:23], v[176:179], v[12:15], 0
    v_mfma_f32_16x16x32_bf16 v[24:27], v[184:187], v[12:15], 0
    v_mfma_f32_16x16x32_bf16 v[20:23], v[180:183], v[16:19], v[20:23]
    v_mfma_f32_16x16x32_bf16 v[24:27], v[188:191], v[16:19], v[24:27]
    s_nop 6
    v_mov_b32_dpp v8, v20 quad_perm:[0,1,0,1] row_mask:0xf bank_mask:0xf
    v_mov_b32_dpp v9, v22 quad_perm:[0,1,0,1] row_mask:0xf bank_mask:0xf
    v_mov_b32_dpp v10, v24 quad_perm:[0,1,0,1] row_mask:0xf bank_mask:0xf
    v_mov_b32_dpp v11, v26 quad_perm:[0,1,0,1] row_mask:0xf bank_mask:0xf
    v_add_f32_dpp v8, v21, v8 quad_perm:[2,3,2,3] row_mask:0xf bank_mask:0xf
    v_add_f32_dpp v9, v23, v9 quad_perm:[2,3,2,3] row_mask:0xf bank_mask:0xf
    v_add_f32_dpp v10, v25, v10 quad_perm:[2,3,2,3] row_mask:0xf bank_mask:0xf
    v_add_f32_dpp v11, v27, v11 quad_perm:[2,3,2,3] row_mask:0xf bank_mask:0xf
    v_cvt_pk_bf16_f32 v28, v8, v9
    v_cvt_pk_bf16_f32 v29, v10, v11
    v_lshlrev_b32 v8, 16, v28
    v_and_b32 v9, s60, v28
    v_lshlrev_b32 v10, 16, v29
    v_and_b32 v11, s60, v29
    v_mul_f32 v8, s69, v8
    v_mul_f32 v9, s69, v9
    v_mul_f32 v10, s69, v10
    v_mul_f32 v11, s69, v11
    v_cvt_pk_bf16_f32 v28, v8, v9
    v_cvt_pk_bf16_f32 v29, v10, v11
    v_lshlrev_b32 v8, 16, v28
    v_and_b32 v9, s60, v28
    v_lshlrev_b32 v10, 16, v29
    v_and_b32 v11, s60, v29
    s_mov_b64 exec, s[26:27]
    ds_write_b64 v31, v[28:29] offset:64
    s_mov_b64 exec, -1
    v_max3_f32 v7, v8, v9, v7
    v_max3_f32 v7, v10, v11, v7
    v_add_u32 v31, 512, v31
    s_waitcnt vmcnt(36)
    v_mfma_f32_16x16x32_bf16 v[20:23], v[192:195], v[12:15], 0
    v_mfma_f32_16x16x32_bf16 v[24:27], v[200:203], v[12:15], 0
    v_mfma_f32_16x16x32_bf16 v[20:23], v[196:199], v[16:19], v[20:23]
    v_mfma_f32_16x16x32_bf16 v[24:27], v[204:207], v[16:19], v[24:27]
    s_nop 6
    v_mov_b32_dpp v8, v20 quad_perm:[0,1,0,1] row_mask:0xf bank_mask:0xf
    v_mov_b32_dpp v9, v22 quad_perm:[0,1,0,1] row_mask:0xf bank_mask:0xf
    v_mov_b32_dpp v10, v24 quad_perm:[0,1,0,1] row_mask:0xf bank_mask:0xf
    v_mov_b32_dpp v11, v26 quad_perm:[0,1,0,1] row_mask:0xf bank_mask:0xf
    v_add_f32_dpp v8, v21, v8 quad_perm:[2,3,2,3] row_mask:0xf bank_mask:0xf
    v_add_f32_dpp v9, v23, v9 quad_perm:[2,3,2,3] row_mask:0xf bank_mask:0xf
    v_add_f32_dpp v10, v25, v10 quad_perm:[2,3,2,3] row_mask:0xf bank_mask:0xf
    v_add_f32_dpp v11, v27, v11 quad_perm:[2,3,2,3] row_mask:0xf bank_mask:0xf
    v_cvt_pk_bf16_f32 v28, v8, v9
    v_cvt_pk_bf16_f32 v29, v10, v11
    v_lshlrev_b32 v8, 16, v28
    v_and_b32 v9, s60, v28
    v_lshlrev_b32 v10, 16, v29
    v_and_b32 v11, s60, v29
    v_mul_f32 v8, s69, v8
    v_mul_f32 v9, s69, v9
    v_mul_f32 v10, s69, v10
    v_mul_f32 v11, s69, v11
    v_cvt_pk_bf16_f32 v28, v8, v9
    v_cvt_pk_bf16_f32 v29, v10, v11
    v_lshlrev_b32 v8, 16, v28
    v_and_b32 v9, s60, v28
    v_lshlrev_b32 v10, 16, v29
    v_and_b32 v11, s60, v29
    s_mov_b64 exec, s[26:27]
    ds_write_b64 v31, v[28:29] offset:0
    s_mov_b64 exec, -1
    v_max3_f32 v7, v8, v9, v7
    v_max3_f32 v7, v10, v11, v7
    s_waitcnt vmcnt(32)
    v_mfma_f32_16x16x32_bf16 v[20:23], v[208:211], v[12:15], 0
    v_mfma_f32_16x16x32_bf16 v[24:27], v[216:219], v[12:15], 0
    v_mfma_f32_16x16x32_bf16 v[20:23], v[212:215], v[16:19], v[20:23]
    v_mfma_f32_16x16x32_bf16 v[24:27], v[220:223], v[16:19], v[24:27]
    s_nop 6
    v_mov_b32_dpp v8, v20 quad_perm:[0,1,0,1] row_mask:0xf bank_mask:0xf
    v_mov_b32_dpp v9, v22 quad_perm:[0,1,0,1] row_mask:0xf bank_mask:0xf
    v_mov_b32_dpp v10, v24 quad_perm:[0,1,0,1] row_mask:0xf bank_mask:0xf
    v_mov_b32_dpp v11, v26 quad_perm:[0,1,0,1] row_mask:0xf bank_mask:0xf
    v_add_f32_dpp v8, v21, v8 quad_perm:[2,3,2,3] row_mask:0xf bank_mask:0xf
    v_add_f32_dpp v9, v23, v9 quad_perm:[2,3,2,3] row_mask:0xf bank_mask:0xf
    v_add_f32_dpp v10, v25, v10 quad_perm:[2,3,2,3] row_mask:0xf bank_mask:0xf
    v_add_f32_dpp v11, v27, v11 quad_perm:[2,3,2,3] row_mask:0xf bank_mask:0xf
    v_cvt_pk_bf16_f32 v28, v8, v9
    v_cvt_pk_bf16_f32 v29, v10, v11
    v_lshlrev_b32 v8, 16, v28
    v_and_b32 v9, s60, v28
    v_lshlrev_b32 v10, 16, v29
    v_and_b32 v11, s60, v29
    v_mul_f32 v8, s69, v8
    v_mul_f32 v9, s69, v9
    v_mul_f32 v10, s69, v10
    v_mul_f32 v11, s69, v11
    v_cvt_pk_bf16_f32 v28, v8, v9
    v_cvt_pk_bf16_f32 v29, v10, v11
    v_lshlrev_b32 v8, 16, v28
    v_and_b32 v9, s60, v28
    v_lshlrev_b32 v10, 16, v29
    v_and_b32 v11, s60, v29
    s_mov_b64 exec, s[26:27]
    ds_write_b64 v31, v[28:29] offset:64
    s_mov_b64 exec, -1
    v_max3_f32 v7, v8, v9, v7
    v_max3_f32 v7, v10, v11, v7
    v_add_u32 v31, 512, v31
    s_waitcnt vmcnt(28)
    v_mfma_f32_16x16x32_bf16 v[20:23], v[224:227], v[12:15], 0
    v_mfma_f32_16x16x32_bf16 v[24:27], v[232:235], v[12:15], 0
    v_mfma_f32_16x16x32_bf16 v[20:23], v[228:231], v[16:19], v[20:23]
    v_mfma_f32_16x16x32_bf16 v[24:27], v[236:239], v[16:19], v[24:27]
    s_nop 6
    v_mov_b32_dpp v8, v20 quad_perm:[0,1,0,1] row_mask:0xf bank_mask:0xf
    v_mov_b32_dpp v9, v22 quad_perm:[0,1,0,1] row_mask:0xf bank_mask:0xf
    v_mov_b32_dpp v10, v24 quad_perm:[0,1,0,1] row_mask:0xf bank_mask:0xf
    v_mov_b32_dpp v11, v26 quad_perm:[0,1,0,1] row_mask:0xf bank_mask:0xf
    v_add_f32_dpp v8, v21, v8 quad_perm:[2,3,2,3] row_mask:0xf bank_mask:0xf
    v_add_f32_dpp v9, v23, v9 quad_perm:[2,3,2,3] row_mask:0xf bank_mask:0xf
    v_add_f32_dpp v10, v25, v10 quad_perm:[2,3,2,3] row_mask:0xf bank_mask:0xf
    v_add_f32_dpp v11, v27, v11 quad_perm:[2,3,2,3] row_mask:0xf bank_mask:0xf
    v_cvt_pk_bf16_f32 v28, v8, v9
    v_cvt_pk_bf16_f32 v29, v10, v11
    v_lshlrev_b32 v8, 16, v28
    v_and_b32 v9, s60, v28
    v_lshlrev_b32 v10, 16, v29
    v_and_b32 v11, s60, v29
    v_mul_f32 v8, s69, v8
    v_mul_f32 v9, s69, v9
    v_mul_f32 v10, s69, v10
    v_mul_f32 v11, s69, v11
    v_cvt_pk_bf16_f32 v28, v8, v9
    v_cvt_pk_bf16_f32 v29, v10, v11
    v_lshlrev_b32 v8, 16, v28
    v_and_b32 v9, s60, v28
    v_lshlrev_b32 v10, 16, v29
    v_and_b32 v11, s60, v29
    s_mov_b64 exec, s[26:27]
    ds_write_b64 v31, v[28:29] offset:0
    s_mov_b64 exec, -1
    v_max3_f32 v7, v8, v9, v7
    v_max3_f32 v7, v10, v11, v7
    s_waitcnt vmcnt(24)
    v_mfma_f32_16x16x32_bf16 v[20:23], v[240:243], v[12:15], 0
    v_mfma_f32_16x16x32_bf16 v[24:27], v[248:251], v[12:15], 0
    v_mfma_f32_16x16x32_bf16 v[20:23], v[244:247], v[16:19], v[20:23]
    v_mfma_f32_16x16x32_bf16 v[24:27], v[252:255], v[16:19], v[24:27]
    s_nop 6
    v_mov_b32_dpp v8, v20 quad_perm:[0,1,0,1] row_mask:0xf bank_mask:0xf
    v_mov_b32_dpp v9, v22 quad_perm:[0,1,0,1] row_mask:0xf bank_mask:0xf
    v_mov_b32_dpp v10, v24 quad_perm:[0,1,0,1] row_mask:0xf bank_mask:0xf
    v_mov_b32_dpp v11, v26 quad_perm:[0,1,0,1] row_mask:0xf bank_mask:0xf
    v_add_f32_dpp v8, v21, v8 quad_perm:[2,3,2,3] row_mask:0xf bank_mask:0xf
    v_add_f32_dpp v9, v23, v9 quad_perm:[2,3,2,3] row_mask:0xf bank_mask:0xf
    v_add_f32_dpp v10, v25, v10 quad_perm:[2,3,2,3] row_mask:0xf bank_mask:0xf
    v_add_f32_dpp v11, v27, v11 quad_perm:[2,3,2,3] row_mask:0xf bank_mask:0xf
    v_cvt_pk_bf16_f32 v28, v8, v9
    v_cvt_pk_bf16_f32 v29, v10, v11
    v_lshlrev_b32 v8, 16, v28
    v_and_b32 v9, s60, v28
    v_lshlrev_b32 v10, 16, v29
    v_and_b32 v11, s60, v29
    v_mul_f32 v8, s69, v8
    v_mul_f32 v9, s69, v9
    v_mul_f32 v10, s69, v10
    v_mul_f32 v11, s69, v11
    v_cvt_pk_bf16_f32 v28, v8, v9
    v_cvt_pk_bf16_f32 v29, v10, v11
    v_lshlrev_b32 v8, 16, v28
    v_and_b32 v9, s60, v28
    v_lshlrev_b32 v10, 16, v29
    v_and_b32 v11, s60, v29
    s_mov_b64 exec, s[26:27]
    ds_write_b64 v31, v[28:29] offset:64
    s_mov_b64 exec, -1
    v_max3_f32 v7, v8, v9, v7
    v_max3_f32 v7, v10, v11, v7
    v_add_u32 v31, 512, v31
    s_waitcnt vmcnt(20)
    v_mfma_f32_16x16x32_bf16 v[20:23], v[32:35], v[12:15], 0
    v_mfma_f32_16x16x32_bf16 v[24:27], v[40:43], v[12:15], 0
    v_mfma_f32_16x16x32_bf16 v[20:23], v[36:39], v[16:19], v[20:23]
    v_mfma_f32_16x16x32_bf16 v[24:27], v[44:47], v[16:19], v[24:27]
    s_nop 6
    v_mov_b32_dpp v8, v20 quad_perm:[0,1,0,1] row_mask:0xf bank_mask:0xf
    v_mov_b32_dpp v9, v22 quad_perm:[0,1,0,1] row_mask:0xf bank_mask:0xf
    v_mov_b32_dpp v10, v24 quad_perm:[0,1,0,1] row_mask:0xf bank_mask:0xf
    v_mov_b32_dpp v11, v26 quad_perm:[0,1,0,1] row_mask:0xf bank_mask:0xf
    v_add_f32_dpp v8, v21, v8 quad_perm:[2,3,2,3] row_mask:0xf bank_mask:0xf
    v_add_f32_dpp v9, v23, v9 quad_perm:[2,3,2,3] row_mask:0xf bank_mask:0xf
    v_add_f32_dpp v10, v25, v10 quad_perm:[2,3,2,3] row_mask:0xf bank_mask:0xf
    v_add_f32_dpp v11, v27, v11 quad_perm:[2,3,2,3] row_mask:0xf bank_mask:0xf
    v_cvt_pk_bf16_f32 v28, v8, v9
    v_cvt_pk_bf16_f32 v29, v10, v11
    v_lshlrev_b32 v8, 16, v28
    v_and_b32 v9, s60, v28
    v_lshlrev_b32 v10, 16, v29
    v_and_b32 v11, s60, v29
    v_mul_f32 v8, s69, v8
    v_mul_f32 v9, s69, v9
    v_mul_f32 v10, s69, v10
    v_mul_f32 v11, s69, v11
    v_cvt_pk_bf16_f32 v28, v8, v9
    v_cvt_pk_bf16_f32 v29, v10, v11
    v_lshlrev_b32 v8, 16, v28
    v_and_b32 v9, s60, v28
    v_lshlrev_b32 v10, 16, v29
    v_and_b32 v11, s60, v29
    s_mov_b64 exec, s[26:27]
    ds_write_b64 v31, v[28:29] offset:0
    s_mov_b64 exec, -1
    v_max3_f32 v7, v8, v9, v7
    v_max3_f32 v7, v10, v11, v7
    s_waitcnt vmcnt(16)
    v_mfma_f32_16x16x32_bf16 v[20:23], v[48:51], v[12:15], 0
    v_mfma_f32_16x16x32_bf16 v[24:27], v[56:59], v[12:15], 0
    v_mfma_f32_16x16x32_bf16 v[20:23], v[52:55], v[16:19], v[20:23]
    v_mfma_f32_16x16x32_bf16 v[24:27], v[60:63], v[16:19], v[24:27]
    s_nop 6
    v_mov_b32_dpp v8, v20 quad_perm:[0,1,0,1] row_mask:0xf bank_mask:0xf
    v_mov_b32_dpp v9, v22 quad_perm:[0,1,0,1] row_mask:0xf bank_mask:0xf
    v_mov_b32_dpp v10, v24 quad_perm:[0,1,0,1] row_mask:0xf bank_mask:0xf
    v_mov_b32_dpp v11, v26 quad_perm:[0,1,0,1] row_mask:0xf bank_mask:0xf
    v_add_f32_dpp v8, v21, v8 quad_perm:[2,3,2,3] row_mask:0xf bank_mask:0xf
    v_add_f32_dpp v9, v23, v9 quad_perm:[2,3,2,3] row_mask:0xf bank_mask:0xf
    v_add_f32_dpp v10, v25, v10 quad_perm:[2,3,2,3] row_mask:0xf bank_mask:0xf
    v_add_f32_dpp v11, v27, v11 quad_perm:[2,3,2,3] row_mask:0xf bank_mask:0xf
    v_cvt_pk_bf16_f32 v28, v8, v9
    v_cvt_pk_bf16_f32 v29, v10, v11
    v_lshlrev_b32 v8, 16, v28
    v_and_b32 v9, s60, v28
    v_lshlrev_b32 v10, 16, v29
    v_and_b32 v11, s60, v29
    v_mul_f32 v8, s69, v8
    v_mul_f32 v9, s69, v9
    v_mul_f32 v10, s69, v10
    v_mul_f32 v11, s69, v11
    v_cvt_pk_bf16_f32 v28, v8, v9
    v_cvt_pk_bf16_f32 v29, v10, v11
    v_lshlrev_b32 v8, 16, v28
    v_and_b32 v9, s60, v28
    v_lshlrev_b32 v10, 16, v29
    v_and_b32 v11, s60, v29
    s_mov_b64 exec, s[26:27]
    ds_write_b64 v31, v[28:29] offset:64
    s_mov_b64 exec, -1
    v_max3_f32 v7, v8, v9, v7
    v_max3_f32 v7, v10, v11, v7
    v_mov_b32 v52, 0xffff
    v_and_b32 v56, 2, v3
    v_lshlrev_b32 v56, 3, v56
    v_lshlrev_b32 v52, v56, v52
    v_mov_b32 v53, 133440
    v_mov_b32 v54, 1
    v_mov_b32 v32, 0
    v_mov_b32 v33, 0
    v_mov_b32 v34, 0
    v_mov_b32 v35, 0
    v_mov_b32 v36, 0
    v_mov_b32 v37, 0
    v_mov_b32 v38, 0
    v_mov_b32 v39, 0
    v_mov_b32 v40, 0
    v_mov_b32 v41, 0
    v_mov_b32 v42, 0
    v_mov_b32 v43, 0
    v_mov_b32 v44, 0
    v_mov_b32 v45, 0
    v_mov_b32 v46, 0
    v_mov_b32 v47, 0
    v_mov_b32 v48, 0
    v_mov_b32 v49, 0
    v_mov_b32 v50, 0
    v_mov_b32 v51, 0
    v_mov_b32 v192, 0
    v_mov_b32 v193, 0
    v_mov_b32 v194, 0
    v_mov_b32 v195, 0
    v_mov_b32 v196, 0
    v_mov_b32 v197, 0
    v_mov_b32 v198, 0
    v_mov_b32 v199, 0
    v_mov_b32 v200, 0
    v_mov_b32 v201, 0
    v_mov_b32 v202, 0
    v_mov_b32 v203, 0
    v_mov_b32 v204, 0
    v_mov_b32 v205, 0
    v_mov_b32 v206, 0
    v_mov_b32 v207, 0
    v_and_b32 v56, 1, v2
    v_lshlrev_b32 v56, 5, v56
    v_lshrrev_b32 v57, 1, v2
    v_lshl_add_u32 v56, v57, 7, v56
    v_lshrrev_b32 v240, 1, v3
    v_lshl_add_u32 v240, v240, 8, v56
    v_and_b32 v57, 1, v3
    v_lshl_add_u32 v240, v57, 4, v240
    v_lshl_add_u32 v56, v57, 8, v56
    v_and_b32 v57, 2, v3
    v_lshl_add_u32 v56, v57, 3, v56
    v_add_u32 v56, 132928, v56
    ds_read_b128 v[224:227], v56
    ds_read_b128 v[228:231], v56 offset:64
    v_and_b32 v57, 4, v3
    v_lshl_add_u32 v241, v57, 6, v5
    v_xor_b32 v242, 256, v241
    s_mov_b32 s56, 0
    s_mov_b32 s57, 0
    v_mov_b32 v232, 0
    v_mov_b32 v233, 0
    v_mov_b32 v234, 0
    v_mov_b32 v235, 0
    v_mov_b32 v236, 0
    v_mov_b32 v237, 0
    v_mov_b32 v238, 0
    v_mov_b32 v239, 0
    s_waitcnt lgkmcnt(0)
    s_lshl_b32 s63, s15, 10
    s_add_u32 s63, s63, 128768
    v_lshlrev_b32 v160, 5, v3
    v_lshl_add_u32 v160, v2, 3, v160
    v_add_u32 v160, s63, v160
    v_lshlrev_b32 v163, 4, v1
    v_add_u32 v163, 128768, v163
    v_lshrrev_b32 v162, 3, v1
    v_lshlrev_b32 v162, 11, v162
    v_and_b32 v56, 1, v1
    v_lshl_add_u32 v162, v56, 10, v162
    v_bfe_u32 v56, v1, 1, 2
    v_lshl_add_u32 v162, v56, 8, v162
    v_lshrrev_b32 v164, 5, v1
    v_lshlrev_b32 v164, 3, v164
    v_add_u32 v164, 133488, v164
    v_and_b32 v165, 1, v3
    v_lshlrev_b32 v165, 4, v165
    v_add_u32 v165, 133504, v165
    v_lshl_add_u32 v161, s15, 2, v165
    v_mov_b32 v173, s8
    v_mov_b32 v175, s8
    s_lshl_b32 s74, s10, 7
    s_add_u32 s74, s74, s67
    s_lshl_b32 s74, s74, 3
    s_add_u32 s74, s74, s11
    s_lshl_b32 s74, s74, 4
    s_add_u32 s74, s74, 524288
L_ktop:
    s_mov_b32 s31, 0
    s_cmp_lg_u32 s70, 0
    s_cbranch_scc1 L_turn
    v_add_u32 v31, s24, v30
    s_mov_b32 s58, s56
    s_cmp_lt_u32 s71, 2
    s_cbranch_scc1 L_wk00
    s_waitcnt vmcnt(4)
L_wk00:
    s_waitcnt vmcnt(12)
    s_mov_b64 exec, 1
    ds_add_rtn_u32 v56, v53, v54 offset:16
    ds_read_b32 v57, v53 offset:12
    s_mov_b64 exec, -1
    v_mfma_f32_16x16x32_bf16 v[24:27], v[72:75], v[12:15], 0
    s_cmp_eq_u32 s58, 0
    s_cbranch_scc1 L_qa00
    v_mfma_f32_16x16x32_bf16 v[20:23], v[64:67], v[224:227], 0
    v_mfma_f32_16x16x32_bf16 v[20:23], v[68:71], v[228:231], v[20:23]
    s_branch L_qb00
L_qa00:
    v_mfma_f32_16x16x32_bf16 v[20:23], v[64:67], v[12:15], 0
    v_mfma_f32_16x16x32_bf16 v[20:23], v[68:71], v[16:19], v[20:23]
L_qb00:
    v_mfma_f32_16x16x32_bf16 v[24:27], v[76:79], v[16:19], v[24:27]
    s_waitcnt lgkmcnt(0)
    v_readfirstlane_b32 s76, v56
    v_readfirstlane_b32 s29, v57
    s_add_u32 s76, s76, 36
    s_max_u32 s28, s30, s29
    s_bitcmp1_b32 s76, 0
    s_cselect_b32 s64, 0x6000, 0
    s_xor_b32 s72, s64, s79
    s_bitcmp1_b32 s76, 1
    s_cselect_b32 s64, 0x15000, 0
    s_xor_b32 s72, s64, s72
    s_bitcmp1_b32 s76, 2
    s_cselect_b32 s64, 0x4000, 0
    s_xor_b32 s72, s64, s72
    s_bitcmp1_b32 s76, 3
    s_cselect_b32 s64, 0x98000, 0
    s_xor_b32 s72, s64, s72
    s_bitcmp1_b32 s76, 4
    s_cselect_b32 s64, 0xcc000, 0
    s_xor_b32 s72, s64, s72
    s_bitcmp1_b32 s76, 5
    s_cselect_b32 s64, 0x151000, 0
    s_xor_b32 s72, s64, s72
    s_bitcmp1_b32 s76, 6
    s_cselect_b32 s64, 0x28000, 0
    s_xor_b32 s72, s64, s72
    s_lshr_b32 s70, s76, 7
    s_and_b32 s24, s76, 127
    s_lshl_b32 s24, s24, 7
    s_add_u32 s76, s76, 4
    s_cmp_lt_u32 s76, s28
    s_cselect_b32 s77, 0x20000000, 0
    s_cselect_b32 s56, 0, 1
    s_cmp_eq_u32 s70, 0
    s_cbranch_scc1 L_ik00
    s_cmp_eq_u32 s70, 1
    s_cbranch_scc0 L_id00
    s_cmp_eq_u32 s56, 0
    s_cbranch_scc1 L_sp_1a
    buffer_load_dwordx4 v[64:67], v241, s[48:51], s72 offen offset:0 nt
    buffer_load_dwordx4 v[68:71], v242, s[48:51], s72 offen offset:0 nt
    s_branch L_sp_1b
L_sp_1a:
    buffer_load_dwordx4 v[64:67], v5, s[48:51], s72 offen offset:0 nt
    buffer_load_dwordx4 v[68:71], v5, s[48:51], s72 offen offset:256 nt
L_sp_1b:
    buffer_load_dwordx4 v[72:75], v5, s[48:51], s72 offen offset:2048 nt
    buffer_load_dwordx4 v[76:79], v5, s[48:51], s72 offen offset:2304 nt
    s_xor_b32 s72, s72, 0x10000
    s_branch L_id00
L_ik00:
    s_cmp_eq_u32 s56, 0
    s_cbranch_scc1 L_sp_2a
    buffer_load_dwordx4 v[64:67], v240, s[44:47], s72 offen offset:0 nt
    buffer_load_dwordx4 v[68:71], v240, s[44:47], s72 offen offset:64 nt
    s_branch L_sp_2b
L_sp_2a:
    buffer_load_dwordx4 v[64:67], v4, s[44:47], s72 offen offset:0 nt
    buffer_load_dwordx4 v[68:71], v4, s[44:47], s72 offen offset:128 nt
L_sp_2b:
    buffer_load_dwordx4 v[72:75], v4, s[44:47], s72 offen offset:2048 nt
    buffer_load_dwordx4 v[76:79], v4, s[44:47], s72 offen offset:2176 nt
    s_xor_b32 s72, s72, 0x10000
L_id00:
    v_mov_b32_dpp v8, v20 quad_perm:[0,1,0,1] row_mask:0xf bank_mask:0xf
    v_mov_b32_dpp v9, v22 quad_perm:[0,1,0,1] row_mask:0xf bank_mask:0xf
    v_mov_b32_dpp v10, v24 quad_perm:[0,1,0,1] row_mask:0xf bank_mask:0xf
    v_mov_b32_dpp v11, v26 quad_perm:[0,1,0,1] row_mask:0xf bank_mask:0xf
    v_add_f32_dpp v8, v21, v8 quad_perm:[2,3,2,3] row_mask:0xf bank_mask:0xf
    v_add_f32_dpp v9, v23, v9 quad_perm:[2,3,2,3] row_mask:0xf bank_mask:0xf
    v_add_f32_dpp v10, v25, v10 quad_perm:[2,3,2,3] row_mask:0xf bank_mask:0xf
    v_add_f32_dpp v11, v27, v11 quad_perm:[2,3,2,3] row_mask:0xf bank_mask:0xf
    v_cvt_pk_bf16_f32 v28, v8, v9
    v_cvt_pk_bf16_f32 v29, v10, v11
    v_lshlrev_b32 v8, 16, v28
    v_and_b32 v9, s60, v28
    v_lshlrev_b32 v10, 16, v29
    v_and_b32 v11, s60, v29
    v_mul_f32 v8, s69, v8
    v_mul_f32 v9, s69, v9
    v_mul_f32 v10, s69, v10
    v_mul_f32 v11, s69, v11
    v_cvt_pk_bf16_f32 v28, v8, v9
    v_cvt_pk_bf16_f32 v29, v10, v11
    v_lshlrev_b32 v8, 16, v28
    v_and_b32 v9, s60, v28
    v_lshlrev_b32 v10, 16, v29
    v_and_b32 v11, s60, v29
    s_mov_b64 exec, s[26:27]
    ds_write_b64 v31, v[28:29] offset:0
    s_mov_b64 exec, -1
    v_max3_f32 v7, v8, v9, v7
    v_max3_f32 v7, v10, v11, v7
    s_cmp_lt_u32 s70, 2
    s_cbranch_scc1 L_wk01
    s_waitcnt vmcnt(8)
    s_cmp_lt_u32 s71, 2
    s_cbranch_scc1 L_wk01
    s_waitcnt vmcnt(0)
L_wk01:
    s_waitcnt vmcnt(12)
    v_mfma_f32_16x16x32_bf16 v[24:27], v[88:91], v[12:15], 0
    s_cmp_eq_u32 s58, 0
    s_cbranch_scc1 L_qa01
    v_mfma_f32_16x16x32_bf16 v[20:23], v[80:83], v[224:227], 0
    v_mfma_f32_16x16x32_bf16 v[20:23], v[84:87], v[228:231], v[20:23]
    s_branch L_qb01
L_qa01:
    v_mfma_f32_16x16x32_bf16 v[20:23], v[80:83], v[12:15], 0
    v_mfma_f32_16x16x32_bf16 v[20:23], v[84:87], v[16:19], v[20:23]
L_qb01:
    v_mfma_f32_16x16x32_bf16 v[24:27], v[92:95], v[16:19], v[24:27]
    s_cmp_eq_u32 s70, 0
    s_cbranch_scc1 L_ik01
    s_cmp_eq_u32 s70, 1
    s_cbranch_scc0 L_id01
    s_cmp_eq_u32 s56, 0
    s_cbranch_scc1 L_sp_3a
    buffer_load_dwordx4 v[80:83], v241, s[48:51], s72 offen offset:0 nt
    buffer_load_dwordx4 v[84:87], v242, s[48:51], s72 offen offset:0 nt
    s_branch L_sp_3b
L_sp_3a:
    buffer_load_dwordx4 v[80:83], v5, s[48:51], s72 offen offset:0 nt
    buffer_load_dwordx4 v[84:87], v5, s[48:51], s72 offen offset:256 nt
L_sp_3b:
    buffer_load_dwordx4 v[88:91], v5, s[48:51], s72 offen offset:2048 nt
    buffer_load_dwordx4 v[92:95], v5, s[48:51], s72 offen offset:2304 nt
    s_branch L_id01
L_ik01:
    s_cmp_eq_u32 s56, 0
    s_cbranch_scc1 L_sp_4a
    buffer_load_dwordx4 v[80:83], v240, s[44:47], s72 offen offset:0 nt
    buffer_load_dwordx4 v[84:87], v240, s[44:47], s72 offen offset:64 nt
    s_branch L_sp_4b
L_sp_4a:
    buffer_load_dwordx4 v[80:83], v4, s[44:47], s72 offen offset:0 nt
    buffer_load_dwordx4 v[84:87], v4, s[44:47], s72 offen offset:128 nt
L_sp_4b:
    buffer_load_dwordx4 v[88:91], v4, s[44:47], s72 offen offset:2048 nt
    buffer_load_dwordx4 v[92:95], v4, s[44:47], s72 offen offset:2176 nt
L_id01:
    s_nop 2
    v_mov_b32_dpp v8, v20 quad_perm:[0,1,0,1] row_mask:0xf bank_mask:0xf
    v_mov_b32_dpp v9, v22 quad_perm:[0,1,0,1] row_mask:0xf bank_mask:0xf
    v_mov_b32_dpp v10, v24 quad_perm:[0,1,0,1] row_mask:0xf bank_mask:0xf
    v_mov_b32_dpp v11, v26 quad_perm:[0,1,0,1] row_mask:0xf bank_mask:0xf
    v_add_f32_dpp v8, v21, v8 quad_perm:[2,3,2,3] row_mask:0xf bank_mask:0xf
    v_add_f32_dpp v9, v23, v9 quad_perm:[2,3,2,3] row_mask:0xf bank_mask:0xf
    v_add_f32_dpp v10, v25, v10 quad_perm:[2,3,2,3] row_mask:0xf bank_mask:0xf
    v_add_f32_dpp v11, v27, v11 quad_perm:[2,3,2,3] row_mask:0xf bank_mask:0xf
    v_cvt_pk_bf16_f32 v28, v8, v9
    v_cvt_pk_bf16_f32 v29, v10, v11
    v_lshlrev_b32 v8, 16, v28
    v_and_b32 v9, s60, v28
    v_lshlrev_b32 v10, 16, v29
    v_and_b32 v11, s60, v29
    v_mul_f32 v8, s69, v8
    v_mul_f32 v9, s69, v9
    v_mul_f32 v10, s69, v10
    v_mul_f32 v11, s69, v11
    v_cvt_pk_bf16_f32 v28, v8, v9
    v_cvt_pk_bf16_f32 v29, v10, v11
    v_lshlrev_b32 v8, 16, v28
    v_and_b32 v9, s60, v28
    v_lshlrev_b32 v10, 16, v29
    v_and_b32 v11, s60, v29
    s_mov_b64 exec, s[26:27]
    ds_write_b64 v31, v[28:29] offset:64
    s_mov_b64 exec, -1
    v_max3_f32 v7, v8, v9, v7
    v_max3_f32 v7, v10, v11, v7
    s_mov_b32 s31, 1
    s_cmp_lg_u32 s71, 0
    s_cbranch_scc1 L_turn
    v_add_u32 v31, s25, v30
    s_mov_b32 s58, s57
    s_cmp_lt_u32 s70, 2
    s_cbranch_scc1 L_wk10
    s_waitcnt vmcnt(4)
L_wk10:
    s_waitcnt vmcnt(12)
    s_mov_b64 exec, 1
    ds_add_rtn_u32 v56, v53, v54 offset:16
    ds_read_b32 v57, v53 offset:12
    s_mov_b64 exec, -1
    v_mfma_f32_16x16x32_bf16 v[24:27], v[104:107], v[12:15], 0
    s_cmp_eq_u32 s58, 0
    s_cbranch_scc1 L_qa10
    v_mfma_f32_16x16x32_bf16 v[20:23], v[96:99], v[224:227], 0
    v_mfma_f32_16x16x32_bf16 v[20:23], v[100:103], v[228:231], v[20:23]
    s_branch L_qb10
L_qa10:
    v_mfma_f32_16x16x32_bf16 v[20:23], v[96:99], v[12:15], 0
    v_mfma_f32_16x16x32_bf16 v[20:23], v[100:103], v[16:19], v[20:23]
L_qb10:
    v_mfma_f32_16x16x32_bf16 v[24:27], v[108:111], v[16:19], v[24:27]
    s_waitcnt lgkmcnt(0)
    v_readfirstlane_b32 s76, v56
    v_readfirstlane_b32 s29, v57
    s_add_u32 s76, s76, 36
    s_max_u32 s28, s30, s29
    s_bitcmp1_b32 s76, 0
    s_cselect_b32 s64, 0x6000, 0
    s_xor_b32 s73, s64, s79
    s_bitcmp1_b32 s76, 1
    s_cselect_b32 s64, 0x15000, 0
    s_xor_b32 s73, s64, s73
    s_bitcmp1_b32 s76, 2
    s_cselect_b32 s64, 0x4000, 0
    s_xor_b32 s73, s64, s73
    s_bitcmp1_b32 s76, 3
    s_cselect_b32 s64, 0x98000, 0
    s_xor_b32 s73, s64, s73
    s_bitcmp1_b32 s76, 4
    s_cselect_b32 s64, 0xcc000, 0
    s_xor_b32 s73, s64, s73
    s_bitcmp1_b32 s76, 5
    s_cselect_b32 s64, 0x151000, 0
    s_xor_b32 s73, s64, s73
    s_bitcmp1_b32 s76, 6
    s_cselect_b32 s64, 0x28000, 0
    s_xor_b32 s73, s64, s73
    s_lshr_b32 s71, s76, 7
    s_and_b32 s25, s76, 127
    s_lshl_b32 s25, s25, 7
    s_add_u32 s76, s76, 4
    s_cmp_lt_u32 s76, s28
    s_cselect_b32 s77, 0x20000000, 0
    s_cselect_b32 s57, 0, 1
    s_cmp_eq_u32 s71, 0
    s_cbranch_scc1 L_ik10
    s_cmp_eq_u32 s71, 1
    s_cbranch_scc0 L_id10
    s_cmp_eq_u32 s57, 0
    s_cbranch_scc1 L_sp_5a
    buffer_load_dwordx4 v[96:99], v241, s[48:51], s73 offen offset:0 nt
    buffer_load_dwordx4 v[100:103], v242, s[48:51], s73 offen offset:0 nt
    s_branch L_sp_5b
L_sp_5a:
    buffer_load_dwordx4 v[96:99], v5, s[48:51], s73 offen offset:0 nt
    buffer_load_dwordx4 v[100:103], v5, s[48:51], s73 offen offset:256 nt
L_sp_5b:
    buffer_load_dwordx4 v[104:107], v5, s[48:51], s73 offen offset:2048 nt
    buffer_load_dwordx4 v[108:111], v5, s[48:51], s73 offen offset:2304 nt
    s_xor_b32 s73, s73, 0x10000
    s_branch L_id10
L_ik10:
    s_cmp_eq_u32 s57, 0
    s_cbranch_scc1 L_sp_6a
    buffer_load_dwordx4 v[96:99], v240, s[44:47], s73 offen offset:0 nt
    buffer_load_dwordx4 v[100:103], v240, s[44:47], s73 offen offset:64 nt
    s_branch L_sp_6b
L_sp_6a:
    buffer_load_dwordx4 v[96:99], v4, s[44:47], s73 offen offset:0 nt
    buffer_load_dwordx4 v[100:103], v4, s[44:47], s73 offen offset:128 nt
L_sp_6b:
    buffer_load_dwordx4 v[104:107], v4, s[44:47], s73 offen offset:2048 nt
    buffer_load_dwordx4 v[108:111], v4, s[44:47], s73 offen offset:2176 nt
    s_xor_b32 s73, s73, 0x10000
L_id10:
    v_mov_b32_dpp v8, v20 quad_perm:[0,1,0,1] row_mask:0xf bank_mask:0xf
    v_mov_b32_dpp v9, v22 quad_perm:[0,1,0,1] row_mask:0xf bank_mask:0xf
    v_mov_b32_dpp v10, v24 quad_perm:[0,1,0,1] row_mask:0xf bank_mask:0xf
    v_mov_b32_dpp v11, v26 quad_perm:[0,1,0,1] row_mask:0xf bank_mask:0xf
    v_add_f32_dpp v8, v21, v8 quad_perm:[2,3,2,3] row_mask:0xf bank_mask:0xf
    v_add_f32_dpp v9, v23, v9 quad_perm:[2,3,2,3] row_mask:0xf bank_mask:0xf
    v_add_f32_dpp v10, v25, v10 quad_perm:[2,3,2,3] row_mask:0xf bank_mask:0xf
    v_add_f32_dpp v11, v27, v11 quad_perm:[2,3,2,3] row_mask:0xf bank_mask:0xf
    v_cvt_pk_bf16_f32 v28, v8, v9
    v_cvt_pk_bf16_f32 v29, v10, v11
    v_lshlrev_b32 v8, 16, v28
    v_and_b32 v9, s60, v28
    v_lshlrev_b32 v10, 16, v29
    v_and_b32 v11, s60, v29
    v_mul_f32 v8, s69, v8
    v_mul_f32 v9, s69, v9
    v_mul_f32 v10, s69, v10
    v_mul_f32 v11, s69, v11
    v_cvt_pk_bf16_f32 v28, v8, v9
    v_cvt_pk_bf16_f32 v29, v10, v11
    v_lshlrev_b32 v8, 16, v28
    v_and_b32 v9, s60, v28
    v_lshlrev_b32 v10, 16, v29
    v_and_b32 v11, s60, v29
    s_mov_b64 exec, s[26:27]
    ds_write_b64 v31, v[28:29] offset:0
    s_mov_b64 exec, -1
    v_max3_f32 v7, v8, v9, v7
    v_max3_f32 v7, v10, v11, v7
    s_cmp_lt_u32 s71, 2
    s_cbranch_scc1 L_wk11
    s_waitcnt vmcnt(8)
    s_cmp_lt_u32 s70, 2
    s_cbranch_scc1 L_wk11
    s_waitcnt vmcnt(0)
L_wk11:
    s_waitcnt vmcnt(12)
    v_mfma_f32_16x16x32_bf16 v[24:27], v[120:123], v[12:15], 0
    s_cmp_eq_u32 s58, 0
    s_cbranch_scc1 L_qa11
    v_mfma_f32_16x16x32_bf16 v[20:23], v[112:115], v[224:227], 0
    v_mfma_f32_16x16x32_bf16 v[20:23], v[116:119], v[228:231], v[20:23]
    s_branch L_qb11
L_qa11:
    v_mfma_f32_16x16x32_bf16 v[20:23], v[112:115], v[12:15], 0
    v_mfma_f32_16x16x32_bf16 v[20:23], v[116:119], v[16:19], v[20:23]
L_qb11:
    v_mfma_f32_16x16x32_bf16 v[24:27], v[124:127], v[16:19], v[24:27]
    s_cmp_eq_u32 s71, 0
    s_cbranch_scc1 L_ik11
    s_cmp_eq_u32 s71, 1
    s_cbranch_scc0 L_id11
    s_cmp_eq_u32 s57, 0
    s_cbranch_scc1 L_sp_7a
    buffer_load_dwordx4 v[112:115], v241, s[48:51], s73 offen offset:0 nt
    buffer_load_dwordx4 v[116:119], v242, s[48:51], s73 offen offset:0 nt
    s_branch L_sp_7b
L_sp_7a:
    buffer_load_dwordx4 v[112:115], v5, s[48:51], s73 offen offset:0 nt
    buffer_load_dwordx4 v[116:119], v5, s[48:51], s73 offen offset:256 nt
L_sp_7b:
    buffer_load_dwordx4 v[120:123], v5, s[48:51], s73 offen offset:2048 nt
    buffer_load_dwordx4 v[124:127], v5, s[48:51], s73 offen offset:2304 nt
    s_branch L_id11
L_ik11:
    s_cmp_eq_u32 s57, 0
    s_cbranch_scc1 L_sp_8a
    buffer_load_dwordx4 v[112:115], v240, s[44:47], s73 offen offset:0 nt
    buffer_load_dwordx4 v[116:119], v240, s[44:47], s73 offen offset:64 nt
    s_branch L_sp_8b
L_sp_8a:
    buffer_load_dwordx4 v[112:115], v4, s[44:47], s73 offen offset:0 nt
    buffer_load_dwordx4 v[116:119], v4, s[44:47], s73 offen offset:128 nt
L_sp_8b:
    buffer_load_dwordx4 v[120:123], v4, s[44:47], s73 offen offset:2048 nt
    buffer_load_dwordx4 v[124:127], v4, s[44:47], s73 offen offset:2176 nt
L_id11:
    s_nop 2
    v_mov_b32_dpp v8, v20 quad_perm:[0,1,0,1] row_mask:0xf bank_mask:0xf
    v_mov_b32_dpp v9, v22 quad_perm:[0,1,0,1] row_mask:0xf bank_mask:0xf
    v_mov_b32_dpp v10, v24 quad_perm:[0,1,0,1] row_mask:0xf bank_mask:0xf
    v_mov_b32_dpp v11, v26 quad_perm:[0,1,0,1] row_mask:0xf bank_mask:0xf
    v_add_f32_dpp v8, v21, v8 quad_perm:[2,3,2,3] row_mask:0xf bank_mask:0xf
    v_add_f32_dpp v9, v23, v9 quad_perm:[2,3,2,3] row_mask:0xf bank_mask:0xf
    v_add_f32_dpp v10, v25, v10 quad_perm:[2,3,2,3] row_mask:0xf bank_mask:0xf
    v_add_f32_dpp v11, v27, v11 quad_perm:[2,3,2,3] row_mask:0xf bank_mask:0xf
    v_cvt_pk_bf16_f32 v28, v8, v9
    v_cvt_pk_bf16_f32 v29, v10, v11
    v_lshlrev_b32 v8, 16, v28
    v_and_b32 v9, s60, v28
    v_lshlrev_b32 v10, 16, v29
    v_and_b32 v11, s60, v29
    v_mul_f32 v8, s69, v8
    v_mul_f32 v9, s69, v9
    v_mul_f32 v10, s69, v10
    v_mul_f32 v11, s69, v11
    v_cvt_pk_bf16_f32 v28, v8, v9
    v_cvt_pk_bf16_f32 v29, v10, v11
    v_lshlrev_b32 v8, 16, v28
    v_and_b32 v9, s60, v28
    v_lshlrev_b32 v10, 16, v29
    v_and_b32 v11, s60, v29
    s_mov_b64 exec, s[26:27]
    ds_write_b64 v31, v[28:29] offset:64
    s_mov_b64 exec, -1
    v_max3_f32 v7, v8, v9, v7
    v_max3_f32 v7, v10, v11, v7
    s_branch L_ktop
L_turn:
    v_mov_b32 v56, v7
    s_nop 1
    v_permlane16_swap_b32 v7, v56
    v_max_f32 v7, v7, v56
    v_mov_b32 v56, v7
    s_nop 1
    v_permlane32_swap_b32 v7, v56
    v_max_f32 v7, v7, v56
    ds_write_b32 v161, v7
    s_mov_b64 exec, 1
    ds_add_u32 v53, v54 offset:32
    s_mov_b64 exec, -1
L_kdw:
    ds_read_b32 v56, v53 offset:32
    ds_read_b128 v[8:11], v165
    s_waitcnt lgkmcnt(0)
    v_readfirstlane_b32 s62, v56
    s_nop 0
    s_cmp_eq_u32 s62, 4
    s_cbranch_scc1 L_kdok
    s_sleep 1
    s_sub_u32 s66, s66, 1
    s_cmp_lg_u32 s66, 0
    s_cbranch_scc1 L_kdw
    s_branch L_exit
L_kdok:
    v_max3_f32 v7, v8, v9, v10
    v_max_f32 v7, v7, v11
    v_mul_f32 v7, s61, v7
    s_cmp_eq_u32 s31, 1
    s_cbranch_scc1 L_v1
L_v0:
    s_cmp_lg_u32 s70, 1
    s_cbranch_scc1 L_send
    v_add_u32 v31, s24, v30
    ds_read2_b64 v[20:23], v31 offset0:0 offset1:8
    s_waitcnt lgkmcnt(0)
    s_mov_b32 s58, s56
    v_lshlrev_b32 v8, 16, v20
    v_and_b32 v9, s60, v20
    v_lshlrev_b32 v10, 16, v21
    v_and_b32 v11, s60, v21
    v_fma_f32 v8, v8, s61, -v7
    v_fma_f32 v9, v9, s61, -v7
    v_fma_f32 v10, v10, s61, -v7
    v_fma_f32 v11, v11, s61, -v7
    v_exp_f32 v8, v8
    v_exp_f32 v9, v9
    v_exp_f32 v10, v10
    v_exp_f32 v11, v11
    v_cvt_pk_bf16_f32 v8, v8, v8
    v_cvt_pk_bf16_f32 v9, v9, v9
    v_cvt_pk_bf16_f32 v10, v10, v10
    v_cvt_pk_bf16_f32 v11, v11, v11
    v_and_b32_dpp v32, v8, v52 quad_perm:[0,1,2,3] row_mask:0xf bank_mask:0x1
    v_and_b32_dpp v33, v8, v52 quad_perm:[0,1,2,3] row_mask:0xf bank_mask:0x2
    v_and_b32_dpp v34, v8, v52 quad_perm:[0,1,2,3] row_mask:0xf bank_mask:0x4
    v_and_b32_dpp v35, v8, v52 quad_perm:[0,1,2,3] row_mask:0xf bank_mask:0x8
    v_and_b32_dpp v36, v9, v52 quad_perm:[0,1,2,3] row_mask:0xf bank_mask:0x1
    v_and_b32_dpp v37, v9, v52 quad_perm:[0,1,2,3] row_mask:0xf bank_mask:0x2
    v_and_b32_dpp v38, v9, v52 quad_perm:[0,1,2,3] row_mask:0xf bank_mask:0x4
    v_and_b32_dpp v39, v9, v52 quad_perm:[0,1,2,3] row_mask:0xf bank_mask:0x8
    v_and_b32_dpp v40, v10, v52 quad_perm:[0,1,2,3] row_mask:0xf bank_mask:0x1
    v_and_b32_dpp v41, v10, v52 quad_perm:[0,1,2,3] row_mask:0xf bank_mask:0x2
    v_and_b32_dpp v42, v10, v52 quad_perm:[0,1,2,3] row_mask:0xf bank_mask:0x4
    v_and_b32_dpp v43, v10, v52 quad_perm:[0,1,2,3] row_mask:0xf bank_mask:0x8
    v_and_b32_dpp v44, v11, v52 quad_perm:[0,1,2,3] row_mask:0xf bank_mask:0x1
    v_and_b32_dpp v45, v11, v52 quad_perm:[0,1,2,3] row_mask:0xf bank_mask:0x2
    v_and_b32_dpp v46, v11, v52 quad_perm:[0,1,2,3] row_mask:0xf bank_mask:0x4
    v_and_b32_dpp v47, v11, v52 quad_perm:[0,1,2,3] row_mask:0xf bank_mask:0x8
    v_lshlrev_b32 v8, 16, v22
    v_and_b32 v9, s60, v22
    v_lshlrev_b32 v10, 16, v23
    v_and_b32 v11, s60, v23
    v_fma_f32 v8, v8, s61, -v7
    v_fma_f32 v9, v9, s61, -v7
    v_fma_f32 v10, v10, s61, -v7
    v_fma_f32 v11, v11, s61, -v7
    v_exp_f32 v8, v8
    v_exp_f32 v9, v9
    v_exp_f32 v10, v10
    v_exp_f32 v11, v11
    v_cvt_pk_bf16_f32 v8, v8, v8
    v_cvt_pk_bf16_f32 v9, v9, v9
    v_cvt_pk_bf16_f32 v10, v10, v10
    v_cvt_pk_bf16_f32 v11, v11, v11
    v_and_b32_dpp v192, v8, v52 quad_perm:[0,1,2,3] row_mask:0xf bank_mask:0x1
    v_and_b32_dpp v193, v8, v52 quad_perm:[0,1,2,3] row_mask:0xf bank_mask:0x2
    v_and_b32_dpp v194, v8, v52 quad_perm:[0,1,2,3] row_mask:0xf bank_mask:0x4
    v_and_b32_dpp v195, v8, v52 quad_perm:[0,1,2,3] row_mask:0xf bank_mask:0x8
    v_and_b32_dpp v196, v9, v52 quad_perm:[0,1,2,3] row_mask:0xf bank_mask:0x1
    v_and_b32_dpp v197, v9, v52 quad_perm:[0,1,2,3] row_mask:0xf bank_mask:0x2
    v_and_b32_dpp v198, v9, v52 quad_perm:[0,1,2,3] row_mask:0xf bank_mask:0x4
    v_and_b32_dpp v199, v9, v52 quad_perm:[0,1,2,3] row_mask:0xf bank_mask:0x8
    v_and_b32_dpp v200, v10, v52 quad_perm:[0,1,2,3] row_mask:0xf bank_mask:0x1
    v_and_b32_dpp v201, v10, v52 quad_perm:[0,1,2,3] row_mask:0xf bank_mask:0x2
    v_and_b32_dpp v202, v10, v52 quad_perm:[0,1,2,3] row_mask:0xf bank_mask:0x4
    v_and_b32_dpp v203, v10, v52 quad_perm:[0,1,2,3] row_mask:0xf bank_mask:0x8
    v_and_b32_dpp v204, v11, v52 quad_perm:[0,1,2,3] row_mask:0xf bank_mask:0x1
    v_and_b32_dpp v205, v11, v52 quad_perm:[0,1,2,3] row_mask:0xf bank_mask:0x2
    v_and_b32_dpp v206, v11, v52 quad_perm:[0,1,2,3] row_mask:0xf bank_mask:0x4
    v_and_b32_dpp v207, v11, v52 quad_perm:[0,1,2,3] row_mask:0xf bank_mask:0x8
    s_cmp_lt_u32 s71, 2
    s_cbranch_scc1 L_wv00
    s_waitcnt vmcnt(4)
L_wv00:
    s_waitcnt vmcnt(12)
    s_cmp_lt_u32 s71, 2
    s_cbranch_scc1 L_vm0
    v_mfma_f32_16x16x32_bf16 v[48:51], v[40:43], v[72:75], v[48:51]
    v_mfma_f32_16x16x32_bf16 v[48:51], v[44:47], v[76:79], v[48:51]
    s_cmp_eq_u32 s58, 0
    s_cbranch_scc1 L_pae00
    v_mfma_f32_16x16x32_bf16 v[232:235], v[32:35], v[64:67], v[232:235]
    v_mfma_f32_16x16x32_bf16 v[236:239], v[36:39], v[64:67], v[236:239]
    v_mfma_f32_16x16x32_bf16 v[232:235], v[36:39], v[68:71], v[232:235]
    v_mfma_f32_16x16x32_bf16 v[236:239], v[32:35], v[68:71], v[236:239]
    s_branch L_pbe00
L_pae00:
    v_mfma_f32_16x16x32_bf16 v[48:51], v[32:35], v[64:67], v[48:51]
    v_mfma_f32_16x16x32_bf16 v[48:51], v[36:39], v[68:71], v[48:51]
L_pbe00:
    s_waitcnt vmcnt(0)
    v_mfma_f32_16x16x32_bf16 v[48:51], v[200:203], v[88:91], v[48:51]
    v_mfma_f32_16x16x32_bf16 v[48:51], v[204:207], v[92:95], v[48:51]
    s_cmp_eq_u32 s58, 0
    s_cbranch_scc1 L_pae01
    v_mfma_f32_16x16x32_bf16 v[232:235], v[192:195], v[80:83], v[232:235]
    v_mfma_f32_16x16x32_bf16 v[236:239], v[196:199], v[80:83], v[236:239]
    v_mfma_f32_16x16x32_bf16 v[232:235], v[196:199], v[84:87], v[232:235]
    v_mfma_f32_16x16x32_bf16 v[236:239], v[192:195], v[84:87], v[236:239]
    s_branch L_pbe01
L_pae01:
    v_mfma_f32_16x16x32_bf16 v[48:51], v[192:195], v[80:83], v[48:51]
    v_mfma_f32_16x16x32_bf16 v[48:51], v[196:199], v[84:87], v[48:51]
L_pbe01:
    s_branch L_send
L_vm0:
    s_mov_b64 exec, 1
    ds_add_rtn_u32 v56, v53, v54 offset:16
    ds_read_b32 v57, v53 offset:12
    s_mov_b64 exec, -1
    v_mfma_f32_16x16x32_bf16 v[48:51], v[40:43], v[72:75], v[48:51]
    v_mfma_f32_16x16x32_bf16 v[48:51], v[44:47], v[76:79], v[48:51]
    s_cmp_eq_u32 s58, 0
    s_cbranch_scc1 L_pa00
    v_mfma_f32_16x16x32_bf16 v[232:235], v[32:35], v[64:67], v[232:235]
    v_mfma_f32_16x16x32_bf16 v[236:239], v[36:39], v[64:67], v[236:239]
    v_mfma_f32_16x16x32_bf16 v[232:235], v[36:39], v[68:71], v[232:235]
    v_mfma_f32_16x16x32_bf16 v[236:239], v[32:35], v[68:71], v[236:239]
    s_branch L_pb00
L_pa00:
    v_mfma_f32_16x16x32_bf16 v[48:51], v[32:35], v[64:67], v[48:51]
    v_mfma_f32_16x16x32_bf16 v[48:51], v[36:39], v[68:71], v[48:51]
L_pb00:
    s_waitcnt lgkmcnt(0)
    v_readfirstlane_b32 s76, v56
    v_readfirstlane_b32 s29, v57
    s_add_u32 s76, s76, 36
    s_max_u32 s28, s30, s29
    s_bitcmp1_b32 s76, 0
    s_cselect_b32 s64, 0x6000, 0
    s_xor_b32 s72, s64, s79
    s_bitcmp1_b32 s76, 1
    s_cselect_b32 s64, 0x15000, 0
    s_xor_b32 s72, s64, s72
    s_bitcmp1_b32 s76, 2
    s_cselect_b32 s64, 0x4000, 0
    s_xor_b32 s72, s64, s72
    s_bitcmp1_b32 s76, 3
    s_cselect_b32 s64, 0x98000, 0
    s_xor_b32 s72, s64, s72
    s_bitcmp1_b32 s76, 4
    s_cselect_b32 s64, 0xcc000, 0
    s_xor_b32 s72, s64, s72
    s_bitcmp1_b32 s76, 5
    s_cselect_b32 s64, 0x151000, 0
    s_xor_b32 s72, s64, s72
    s_bitcmp1_b32 s76, 6
    s_cselect_b32 s64, 0x28000, 0
    s_xor_b32 s72, s64, s72
    s_lshr_b32 s70, s76, 7
    s_and_b32 s24, s76, 127
    s_lshl_b32 s24, s24, 7
    s_add_u32 s76, s76, 4
    s_cmp_lt_u32 s76, s28
    s_cselect_b32 s77, 0x20000000, 0
    s_cselect_b32 s56, 0, 1
    s_cmp_eq_u32 s70, 1
    s_cbranch_scc0 L_vd00
    s_cmp_eq_u32 s56, 0
    s_cbranch_scc1 L_sp_9a
    buffer_load_dwordx4 v[64:67], v241, s[48:51], s72 offen offset:0 nt
    buffer_load_dwordx4 v[68:71], v242, s[48:51], s72 offen offset:0 nt
    s_branch L_sp_9b
L_sp_9a:
    buffer_load_dwordx4 v[64:67], v5, s[48:51], s72 offen offset:0 nt
    buffer_load_dwordx4 v[68:71], v5, s[48:51], s72 offen offset:256 nt
L_sp_9b:
    buffer_load_dwordx4 v[72:75], v5, s[48:51], s72 offen offset:2048 nt
    buffer_load_dwordx4 v[76:79], v5, s[48:51], s72 offen offset:2304 nt
    s_xor_b32 s72, s72, 0x10000
L_vd00:
    s_cmp_lt_u32 s70, 2
    s_cbranch_scc1 L_wv01
    s_waitcnt vmcnt(8)
    s_cmp_lt_u32 s71, 2
    s_cbranch_scc1 L_wv01
    s_waitcnt vmcnt(0)
L_wv01:
    s_waitcnt vmcnt(12)
    v_mfma_f32_16x16x32_bf16 v[48:51], v[200:203], v[88:91], v[48:51]
    v_mfma_f32_16x16x32_bf16 v[48:51], v[204:207], v[92:95], v[48:51]
    s_cmp_eq_u32 s58, 0
    s_cbranch_scc1 L_pa01
    v_mfma_f32_16x16x32_bf16 v[232:235], v[192:195], v[80:83], v[232:235]
    v_mfma_f32_16x16x32_bf16 v[236:239], v[196:199], v[80:83], v[236:239]
    v_mfma_f32_16x16x32_bf16 v[232:235], v[196:199], v[84:87], v[232:235]
    v_mfma_f32_16x16x32_bf16 v[236:239], v[192:195], v[84:87], v[236:239]
    s_branch L_pb01
L_pa01:
    v_mfma_f32_16x16x32_bf16 v[48:51], v[192:195], v[80:83], v[48:51]
    v_mfma_f32_16x16x32_bf16 v[48:51], v[196:199], v[84:87], v[48:51]
L_pb01:
    s_cmp_eq_u32 s70, 1
    s_cbranch_scc0 L_vd01
    s_cmp_eq_u32 s56, 0
    s_cbranch_scc1 L_sp_10a
    buffer_load_dwordx4 v[80:83], v241, s[48:51], s72 offen offset:0 nt
    buffer_load_dwordx4 v[84:87], v242, s[48:51], s72 offen offset:0 nt
    s_branch L_sp_10b
L_sp_10a:
    buffer_load_dwordx4 v[80:83], v5, s[48:51], s72 offen offset:0 nt
    buffer_load_dwordx4 v[84:87], v5, s[48:51], s72 offen offset:256 nt
L_sp_10b:
    buffer_load_dwordx4 v[88:91], v5, s[48:51], s72 offen offset:2048 nt
    buffer_load_dwordx4 v[92:95], v5, s[48:51], s72 offen offset:2304 nt
L_vd01:
L_v1:
    s_cmp_lg_u32 s71, 1
    s_cbranch_scc1 L_send
    v_add_u32 v31, s25, v30
    ds_read2_b64 v[20:23], v31 offset0:0 offset1:8
    s_waitcnt lgkmcnt(0)
    s_mov_b32 s58, s57
    v_lshlrev_b32 v8, 16, v20
    v_and_b32 v9, s60, v20
    v_lshlrev_b32 v10, 16, v21
    v_and_b32 v11, s60, v21
    v_fma_f32 v8, v8, s61, -v7
    v_fma_f32 v9, v9, s61, -v7
    v_fma_f32 v10, v10, s61, -v7
    v_fma_f32 v11, v11, s61, -v7
    v_exp_f32 v8, v8
    v_exp_f32 v9, v9
    v_exp_f32 v10, v10
    v_exp_f32 v11, v11
    v_cvt_pk_bf16_f32 v8, v8, v8
    v_cvt_pk_bf16_f32 v9, v9, v9
    v_cvt_pk_bf16_f32 v10, v10, v10
    v_cvt_pk_bf16_f32 v11, v11, v11
    v_and_b32_dpp v32, v8, v52 quad_perm:[0,1,2,3] row_mask:0xf bank_mask:0x1
    v_and_b32_dpp v33, v8, v52 quad_perm:[0,1,2,3] row_mask:0xf bank_mask:0x2
    v_and_b32_dpp v34, v8, v52 quad_perm:[0,1,2,3] row_mask:0xf bank_mask:0x4
    v_and_b32_dpp v35, v8, v52 quad_perm:[0,1,2,3] row_mask:0xf bank_mask:0x8
    v_and_b32_dpp v36, v9, v52 quad_perm:[0,1,2,3] row_mask:0xf bank_mask:0x1
    v_and_b32_dpp v37, v9, v52 quad_perm:[0,1,2,3] row_mask:0xf bank_mask:0x2
    v_and_b32_dpp v38, v9, v52 quad_perm:[0,1,2,3] row_mask:0xf bank_mask:0x4
    v_and_b32_dpp v39, v9, v52 quad_perm:[0,1,2,3] row_mask:0xf bank_mask:0x8
    v_and_b32_dpp v40, v10, v52 quad_perm:[0,1,2,3] row_mask:0xf bank_mask:0x1
    v_and_b32_dpp v41, v10, v52 quad_perm:[0,1,2,3] row_mask:0xf bank_mask:0x2
    v_and_b32_dpp v42, v10, v52 quad_perm:[0,1,2,3] row_mask:0xf bank_mask:0x4
    v_and_b32_dpp v43, v10, v52 quad_perm:[0,1,2,3] row_mask:0xf bank_mask:0x8
    v_and_b32_dpp v44, v11, v52 quad_perm:[0,1,2,3] row_mask:0xf bank_mask:0x1
    v_and_b32_dpp v45, v11, v52 quad_perm:[0,1,2,3] row_mask:0xf bank_mask:0x2
    v_and_b32_dpp v46, v11, v52 quad_perm:[0,1,2,3] row_mask:0xf bank_mask:0x4
    v_and_b32_dpp v47, v11, v52 quad_perm:[0,1,2,3] row_mask:0xf bank_mask:0x8
    v_lshlrev_b32 v8, 16, v22
    v_and_b32 v9, s60, v22
    v_lshlrev_b32 v10, 16, v23
    v_and_b32 v11, s60, v23
    v_fma_f32 v8, v8, s61, -v7
    v_fma_f32 v9, v9, s61, -v7
    v_fma_f32 v10, v10, s61, -v7
    v_fma_f32 v11, v11, s61, -v7
    v_exp_f32 v8, v8
    v_exp_f32 v9, v9
    v_exp_f32 v10, v10
    v_exp_f32 v11, v11
    v_cvt_pk_bf16_f32 v8, v8, v8
    v_cvt_pk_bf16_f32 v9, v9, v9
    v_cvt_pk_bf16_f32 v10, v10, v10
    v_cvt_pk_bf16_f32 v11, v11, v11
    v_and_b32_dpp v192, v8, v52 quad_perm:[0,1,2,3] row_mask:0xf bank_mask:0x1
    v_and_b32_dpp v193, v8, v52 quad_perm:[0,1,2,3] row_mask:0xf bank_mask:0x2
    v_and_b32_dpp v194, v8, v52 quad_perm:[0,1,2,3] row_mask:0xf bank_mask:0x4
    v_and_b32_dpp v195, v8, v52 quad_perm:[0,1,2,3] row_mask:0xf bank_mask:0x8
    v_and_b32_dpp v196, v9, v52 quad_perm:[0,1,2,3] row_mask:0xf bank_mask:0x1
    v_and_b32_dpp v197, v9, v52 quad_perm:[0,1,2,3] row_mask:0xf bank_mask:0x2
    v_and_b32_dpp v198, v9, v52 quad_perm:[0,1,2,3] row_mask:0xf bank_mask:0x4
    v_and_b32_dpp v199, v9, v52 quad_perm:[0,1,2,3] row_mask:0xf bank_mask:0x8
    v_and_b32_dpp v200, v10, v52 quad_perm:[0,1,2,3] row_mask:0xf bank_mask:0x1
    v_and_b32_dpp v201, v10, v52 quad_perm:[0,1,2,3] row_mask:0xf bank_mask:0x2
    v_and_b32_dpp v202, v10, v52 quad_perm:[0,1,2,3] row_mask:0xf bank_mask:0x4
    v_and_b32_dpp v203, v10, v52 quad_perm:[0,1,2,3] row_mask:0xf bank_mask:0x8
    v_and_b32_dpp v204, v11, v52 quad_perm:[0,1,2,3] row_mask:0xf bank_mask:0x1
    v_and_b32_dpp v205, v11, v52 quad_perm:[0,1,2,3] row_mask:0xf bank_mask:0x2
    v_and_b32_dpp v206, v11, v52 quad_perm:[0,1,2,3] row_mask:0xf bank_mask:0x4
    v_and_b32_dpp v207, v11, v52 quad_perm:[0,1,2,3] row_mask:0xf bank_mask:0x8
    s_cmp_lt_u32 s70, 2
    s_cbranch_scc1 L_wv10
    s_waitcnt vmcnt(4)
L_wv10:
    s_waitcnt vmcnt(12)
    s_cmp_lt_u32 s70, 2
    s_cbranch_scc1 L_vm1
    v_mfma_f32_16x16x32_bf16 v[48:51], v[40:43], v[104:107], v[48:51]
    v_mfma_f32_16x16x32_bf16 v[48:51], v[44:47], v[108:111], v[48:51]
    s_cmp_eq_u32 s58, 0
    s_cbranch_scc1 L_pae10
    v_mfma_f32_16x16x32_bf16 v[232:235], v[32:35], v[96:99], v[232:235]
    v_mfma_f32_16x16x32_bf16 v[236:239], v[36:39], v[96:99], v[236:239]
    v_mfma_f32_16x16x32_bf16 v[232:235], v[36:39], v[100:103], v[232:235]
    v_mfma_f32_16x16x32_bf16 v[236:239], v[32:35], v[100:103], v[236:239]
    s_branch L_pbe10
L_pae10:
    v_mfma_f32_16x16x32_bf16 v[48:51], v[32:35], v[96:99], v[48:51]
    v_mfma_f32_16x16x32_bf16 v[48:51], v[36:39], v[100:103], v[48:51]
L_pbe10:
    s_waitcnt vmcnt(0)
    v_mfma_f32_16x16x32_bf16 v[48:51], v[200:203], v[120:123], v[48:51]
    v_mfma_f32_16x16x32_bf16 v[48:51], v[204:207], v[124:127], v[48:51]
    s_cmp_eq_u32 s58, 0
    s_cbranch_scc1 L_pae11
    v_mfma_f32_16x16x32_bf16 v[232:235], v[192:195], v[112:115], v[232:235]
    v_mfma_f32_16x16x32_bf16 v[236:239], v[196:199], v[112:115], v[236:239]
    v_mfma_f32_16x16x32_bf16 v[232:235], v[196:199], v[116:119], v[232:235]
    v_mfma_f32_16x16x32_bf16 v[236:239], v[192:195], v[116:119], v[236:239]
    s_branch L_pbe11
L_pae11:
    v_mfma_f32_16x16x32_bf16 v[48:51], v[192:195], v[112:115], v[48:51]
    v_mfma_f32_16x16x32_bf16 v[48:51], v[196:199], v[116:119], v[48:51]
L_pbe11:
    s_branch L_send
L_vm1:
    s_mov_b64 exec, 1
    ds_add_rtn_u32 v56, v53, v54 offset:16
    ds_read_b32 v57, v53 offset:12
    s_mov_b64 exec, -1
    v_mfma_f32_16x16x32_bf16 v[48:51], v[40:43], v[104:107], v[48:51]
    v_mfma_f32_16x16x32_bf16 v[48:51], v[44:47], v[108:111], v[48:51]
    s_cmp_eq_u32 s58, 0
    s_cbranch_scc1 L_pa10
    v_mfma_f32_16x16x32_bf16 v[232:235], v[32:35], v[96:99], v[232:235]
    v_mfma_f32_16x16x32_bf16 v[236:239], v[36:39], v[96:99], v[236:239]
    v_mfma_f32_16x16x32_bf16 v[232:235], v[36:39], v[100:103], v[232:235]
    v_mfma_f32_16x16x32_bf16 v[236:239], v[32:35], v[100:103], v[236:239]
    s_branch L_pb10
L_pa10:
    v_mfma_f32_16x16x32_bf16 v[48:51], v[32:35], v[96:99], v[48:51]
    v_mfma_f32_16x16x32_bf16 v[48:51], v[36:39], v[100:103], v[48:51]
L_pb10:
    s_waitcnt lgkmcnt(0)
    v_readfirstlane_b32 s76, v56
    v_readfirstlane_b32 s29, v57
    s_add_u32 s76, s76, 36
    s_max_u32 s28, s30, s29
    s_bitcmp1_b32 s76, 0
    s_cselect_b32 s64, 0x6000, 0
    s_xor_b32 s73, s64, s79
    s_bitcmp1_b32 s76, 1
    s_cselect_b32 s64, 0x15000, 0
    s_xor_b32 s73, s64, s73
    s_bitcmp1_b32 s76, 2
    s_cselect_b32 s64, 0x4000, 0
    s_xor_b32 s73, s64, s73
    s_bitcmp1_b32 s76, 3
    s_cselect_b32 s64, 0x98000, 0
    s_xor_b32 s73, s64, s73
    s_bitcmp1_b32 s76, 4
    s_cselect_b32 s64, 0xcc000, 0
    s_xor_b32 s73, s64, s73
    s_bitcmp1_b32 s76, 5
    s_cselect_b32 s64, 0x151000, 0
    s_xor_b32 s73, s64, s73
    s_bitcmp1_b32 s76, 6
    s_cselect_b32 s64, 0x28000, 0
    s_xor_b32 s73, s64, s73
    s_lshr_b32 s71, s76, 7
    s_and_b32 s25, s76, 127
    s_lshl_b32 s25, s25, 7
    s_add_u32 s76, s76, 4
    s_cmp_lt_u32 s76, s28
    s_cselect_b32 s77, 0x20000000, 0
    s_cselect_b32 s57, 0, 1
    s_cmp_eq_u32 s71, 1
    s_cbranch_scc0 L_vd10
    s_cmp_eq_u32 s57, 0
    s_cbranch_scc1 L_sp_11a
    buffer_load_dwordx4 v[96:99], v241, s[48:51], s73 offen offset:0 nt
    buffer_load_dwordx4 v[100:103], v242, s[48:51], s73 offen offset:0 nt
    s_branch L_sp_11b
L_sp_11a:
    buffer_load_dwordx4 v[96:99], v5, s[48:51], s73 offen offset:0 nt
    buffer_load_dwordx4 v[100:103], v5, s[48:51], s73 offen offset:256 nt
L_sp_11b:
    buffer_load_dwordx4 v[104:107], v5, s[48:51], s73 offen offset:2048 nt
    buffer_load_dwordx4 v[108:111], v5, s[48:51], s73 offen offset:2304 nt
    s_xor_b32 s73, s73, 0x10000
L_vd10:
    s_cmp_lt_u32 s71, 2
    s_cbranch_scc1 L_wv11
    s_waitcnt vmcnt(8)
    s_cmp_lt_u32 s70, 2
    s_cbranch_scc1 L_wv11
    s_waitcnt vmcnt(0)
L_wv11:
    s_waitcnt vmcnt(12)
    v_mfma_f32_16x16x32_bf16 v[48:51], v[200:203], v[120:123], v[48:51]
    v_mfma_f32_16x16x32_bf16 v[48:51], v[204:207], v[124:127], v[48:51]
    s_cmp_eq_u32 s58, 0
    s_cbranch_scc1 L_pa11
    v_mfma_f32_16x16x32_bf16 v[232:235], v[192:195], v[112:115], v[232:235]
    v_mfma_f32_16x16x32_bf16 v[236:239], v[196:199], v[112:115], v[236:239]
    v_mfma_f32_16x16x32_bf16 v[232:235], v[196:199], v[116:119], v[232:235]
    v_mfma_f32_16x16x32_bf16 v[236:239], v[192:195], v[116:119], v[236:239]
    s_branch L_pb11
L_pa11:
    v_mfma_f32_16x16x32_bf16 v[48:51], v[192:195], v[112:115], v[48:51]
    v_mfma_f32_16x16x32_bf16 v[48:51], v[196:199], v[116:119], v[48:51]
L_pb11:
    s_cmp_eq_u32 s71, 1
    s_cbranch_scc0 L_vd11
    s_cmp_eq_u32 s57, 0
    s_cbranch_scc1 L_sp_12a
    buffer_load_dwordx4 v[112:115], v241, s[48:51], s73 offen offset:0 nt
    buffer_load_dwordx4 v[116:119], v242, s[48:51], s73 offen offset:0 nt
    s_branch L_sp_12b
L_sp_12a:
    buffer_load_dwordx4 v[112:115], v5, s[48:51], s73 offen offset:0 nt
    buffer_load_dwordx4 v[116:119], v5, s[48:51], s73 offen offset:256 nt
L_sp_12b:
    buffer_load_dwordx4 v[120:123], v5, s[48:51], s73 offen offset:2048 nt
    buffer_load_dwordx4 v[124:127], v5, s[48:51], s73 offen offset:2304 nt
L_vd11:
    s_branch L_v0
L_send:
    s_nop 6
    v_add_f32_dpp v48, v232, v48 quad_perm:[0,1,2,3] row_mask:0xf bank_mask:0x5
    v_add_f32_dpp v49, v233, v49 quad_perm:[0,1,2,3] row_mask:0xf bank_mask:0x5
    v_add_f32_dpp v50, v234, v50 quad_perm:[0,1,2,3] row_mask:0xf bank_mask:0x5
    v_add_f32_dpp v51, v235, v51 quad_perm:[0,1,2,3] row_mask:0xf bank_mask:0x5
    v_add_f32_dpp v48, v236, v48 quad_perm:[0,1,2,3] row_mask:0xf bank_mask:0xa
    v_add_f32_dpp v49, v237, v49 quad_perm:[0,1,2,3] row_mask:0xf bank_mask:0xa
    v_add_f32_dpp v50, v238, v50 quad_perm:[0,1,2,3] row_mask:0xf bank_mask:0xa
    v_add_f32_dpp v51, v239, v51 quad_perm:[0,1,2,3] row_mask:0xf bank_mask:0xa
    ds_write2_b32 v160, v48, v50 offset0:0 offset1:1
    ds_write2_b32 v160, v49, v51 offset0:128 offset1:129
    s_mov_b64 exec, 1
    ds_add_rtn_u32 v56, v53, v54 offset:0
    s_mov_b64 exec, -1
    ds_read_b32 v57, v53 offset:28
    ds_read_b64 v[58:59], v164
    ds_read_b128 v[128:131], v163 offset:0
    ds_read_b128 v[132:135], v163 offset:1024
    ds_read_b128 v[136:139], v163 offset:2048
    ds_read_b128 v[140:143], v163 offset:3072
    s_waitcnt lgkmcnt(4)
    v_readfirstlane_b32 s63, v56
    v_readfirstlane_b32 s62, v57
    s_cmp_lg_u32 s63, 3
    s_cbranch_scc1 L_exit
L_scw:
    v_cmp_ne_u32 vcc, 1, v59
    s_nop 0
    s_cbranch_vccz L_scok
    ds_read_b64 v[58:59], v164
    s_waitcnt lgkmcnt(0)
    s_sleep 1
    s_sub_u32 s66, s66, 1
    s_cmp_lg_u32 s66, 0
    s_cbranch_scc1 L_scw
    s_branch L_exit
L_scok:
    s_waitcnt lgkmcnt(0)
    v_add_f32 v128, v128, v132
    v_add_f32 v136, v136, v140
    v_add_f32 v129, v129, v133
    v_add_f32 v137, v137, v141
    v_add_f32 v130, v130, v134
    v_add_f32 v138, v138, v142
    v_add_f32 v131, v131, v135
    v_add_f32 v139, v139, v143
    v_add_f32 v128, v128, v136
    v_add_f32 v129, v129, v137
    v_add_f32 v130, v130, v138
    v_add_f32 v131, v131, v139
    v_mul_f32 v128, v58, v128
    v_mul_f32 v129, v58, v129
    v_mul_f32 v130, v58, v130
    v_mul_f32 v131, v58, v131
    v_cvt_pk_bf16_f32 v172, v128, v129
    v_cvt_pk_bf16_f32 v174, v130, v131
    s_cmp_eq_u32 s62, 1
    s_cbranch_scc1 L_st_13a
    buffer_store_dwordx4 v[172:175], v162, s[4:7], s74 offen sc1
    s_branch L_st_13b
L_st_13a:
    buffer_store_dwordx4 v[172:175], v162, s[4:7], s74 offen
L_st_13b:
    ds_write_b32 v53, v54 offset:20
    s_branch L_exit
L_helper:
    s_setprio 2
    v_lshlrev_b32 v8, 2, v1
    v_add_u32 v8, 133440, v8
    v_mov_b32 v10, 0
    ds_write_b32 v8, v10
    s_mov_b32 s56, s16
    s_mov_b32 s57, s17
    s_mov_b32 s58, 9216
    s_mov_b32 s59, 0x20000
    s_cmp_eq_u32 s99, 2
    s_cbranch_scc1 L_p1
    s_cmp_eq_u32 s99, 3
    s_cbranch_scc1 L_p2
    s_mov_b32 s4, s42
    s_mov_b32 s5, s43
    s_mov_b32 s6, 8388608
    s_mov_b32 s7, 0x20000
    s_load_dword s9, s[42:43], 0
    s_mov_b32 s62, 0xf5555555
    s_mov_b32 s63, 0x2aaaa
    s_mov_b32 s98, 3
    s_bitcmp1_b32 s62, s13
    s_cselect_b32 s98, 0, s98
    s_bitcmp1_b32 s63, s13
    s_cselect_b32 s98, 1, s98
    s_bfm_b32 s64, s13, 0
    s_and_b32 s63, s63, s64
    s_bcnt1_i32_b32 s77, s63
    s_and_b32 s62, s62, s64
    s_bcnt1_i32_b32 s62, s62
    s_mul_i32 s14, s12, 18
    s_add_u32 s14, s14, s62
    s_waitcnt lgkmcnt(0)
    s_add_u32 s9, s9, 0x9e3779b9
    s_and_b32 s8, s9, 0xbfffbfff
    s_mov_b32 s76, 0
    s_cmp_lg_u32 s15, 3
    s_cbranch_scc1 L_xc_14
    s_getreg_b32 s62, hwreg(HW_REG_XCC_ID)
    s_lshl_b32 s63, s12, 5
    s_add_u32 s63, s63, s13
    s_lshl_b32 s63, s63, 3
    s_add_u32 s63, s63, 65536
    v_mov_b32 v12, s62
    v_mov_b32 v13, s8
    s_mov_b64 exec, 1
    buffer_store_dwordx2 v[12:13], off, s[4:7], s63
    s_mov_b64 exec, -1
L_xc_14:
    s_barrier
    s_branch L_pdone
L_p1:
    s_mov_b32 s4, s42
    s_mov_b32 s5, s43
    s_mov_b32 s6, 8388608
    s_mov_b32 s7, 0x20000
    s_load_dword s9, s[42:43], 0
    s_mov_b32 s62, 0xf5555555
    s_mov_b32 s63, 0x2aaaa
    s_mov_b32 s98, 3
    s_bitcmp1_b32 s62, s13
    s_cselect_b32 s98, 0, s98
    s_bitcmp1_b32 s63, s13
    s_cselect_b32 s98, 1, s98
    s_bfm_b32 s64, s13, 0
    s_and_b32 s63, s63, s64
    s_bcnt1_i32_b32 s77, s63
    s_and_b32 s62, s62, s64
    s_bcnt1_i32_b32 s62, s62
    s_mul_i32 s14, s12, 18
    s_add_u32 s14, s14, s62
    s_waitcnt lgkmcnt(0)
    s_add_u32 s9, s9, 0x9e3779b9
    s_and_b32 s8, s9, 0xbfffbfff
    s_mov_b32 s76, 0
    s_cmp_lg_u32 s15, 3
    s_cbranch_scc1 L_xc_15
    s_getreg_b32 s62, hwreg(HW_REG_XCC_ID)
    s_lshl_b32 s63, s12, 5
    s_add_u32 s63, s63, s13
    s_lshl_b32 s63, s63, 3
    s_add_u32 s63, s63, 65536
    v_mov_b32 v12, s62
    v_mov_b32 v13, s8
    s_mov_b64 exec, 1
    buffer_store_dwordx2 v[12:13], off, s[4:7], s63
    s_mov_b64 exec, -1
L_xc_15:
    v_lshrrev_b32 v5, 2, v3
    v_lshl_add_u32 v6, v2, 3, v5
    v_lshlrev_b32 v6, 7, v6
    v_and_b32 v5, 3, v3
    v_lshl_add_u32 v6, v5, 3, v6
    v_bfe_u32 v5, v1, 3, 2
    v_lshl_add_u32 v6, v5, 5, v6
    v_xor_b32 v168, 0, v6
    v_add_u32 v168, s101, v168
    v_xor_b32 v169, 32, v6
    v_add_u32 v169, s101, v169
    v_xor_b32 v170, 64, v6
    v_add_u32 v170, s101, v170
    v_xor_b32 v171, 96, v6
    v_add_u32 v171, s101, v171
    v_and_b32 v14, 7, v3
    v_mul_u32_u24 v14, 272, v14
    v_lshl_add_u32 v14, v2, 4, v14
    s_mul_i32 s62, s15, 2176
    s_add_u32 s62, s62, 118784
    v_add_u32 v14, s62, v14
    v_and_b32 v5, 1, v2
    v_lshl_add_u32 v5, s15, 1, v5
    v_mul_u32_u24 v15, 272, v5
    v_lshl_add_u32 v15, v3, 4, v15
    v_add_u32 v15, 118784, v15
    v_mul_u32_u24 v5, 0, v5
    v_lshl_add_u32 v5, v3, 4, v5
    v_mov_b32 v37, s8
    v_mov_b32 v39, s8
    s_mov_b32 s68, 0xff00ff
    s_mov_b32 s69, 0xff00ff
    v_and_b32 v15, 7, v1
    v_mul_u32_u24 v15, 272, v15
    v_bfe_u32 v5, v1, 3, 2
    v_lshl_add_u32 v5, s15, 2, v5
    v_lshl_add_u32 v15, v5, 4, v15
    v_add_u32 v15, 118784, v15
    v_lshlrev_b32 v5, 4, v1
    v_lshl_add_u32 v5, s15, 9, v5
    s_lshl_b32 s78, s100, 11
    s_add_u32 s78, s78, 131072
    s_mov_b32 s62, 0xbfb8aa3b
    s_waitcnt vmcnt(0)
    v_and_b32 v6, 7, v1
    v_lshlrev_b32 v6, 5, v6
    v_lshrrev_b32 v8, 3, v1
    v_lshl_add_u32 v6, v8, 2, v6
    ds_bpermute_b32 v16, v6, v16
    ds_bpermute_b32 v17, v6, v17
    ds_bpermute_b32 v20, v6, v20
    ds_bpermute_b32 v21, v6, v21
    ds_bpermute_b32 v24, v6, v24
    ds_bpermute_b32 v25, v6, v25
    ds_bpermute_b32 v28, v6, v28
    ds_bpermute_b32 v29, v6, v29
    ds_bpermute_b32 v32, v6, v32
    ds_bpermute_b32 v33, v6, v33
    s_waitcnt lgkmcnt(0)
    v_lshlrev_b32 v100, 16, v16
    v_and_b32 v101, s60, v16
    v_lshlrev_b32 v102, 16, v17
    v_and_b32 v103, s60, v17
    v_mul_f32 v104, s62, v100
    v_mul_f32 v105, s62, v101
    v_mul_f32 v106, s62, v102
    v_mul_f32 v107, s62, v103
    v_exp_f32 v104, v104
    v_exp_f32 v105, v105
    v_exp_f32 v106, v106
    v_exp_f32 v107, v107
    v_add_f32 v104, 1.0, v104
    v_add_f32 v105, 1.0, v105
    v_add_f32 v106, 1.0, v106
    v_add_f32 v107, 1.0, v107
    v_min_f32 v104, 0x7e800000, v104
    v_min_f32 v105, 0x7e800000, v105
    v_min_f32 v106, 0x7e800000, v106
    v_min_f32 v107, 0x7e800000, v107
    v_rcp_f32 v108, v104
    v_rcp_f32 v109, v105
    v_rcp_f32 v110, v106
    v_rcp_f32 v111, v107
    v_mul_f32 v112, v100, v108
    v_mul_f32 v113, v101, v109
    v_mul_f32 v114, v102, v110
    v_mul_f32 v115, v103, v111
    v_fma_f32 v100, -v112, v104, v100
    v_fma_f32 v101, -v113, v105, v101
    v_fma_f32 v102, -v114, v106, v102
    v_fma_f32 v103, -v115, v107, v103
    v_fmac_f32 v112, v100, v108
    v_fmac_f32 v113, v101, v109
    v_fmac_f32 v114, v102, v110
    v_fmac_f32 v115, v103, v111
    v_cvt_pk_bf16_f32 v16, v112, v113
    v_cvt_pk_bf16_f32 v17, v114, v115
    v_lshlrev_b32 v100, 16, v20
    v_and_b32 v101, s60, v20
    v_lshlrev_b32 v102, 16, v21
    v_and_b32 v103, s60, v21
    v_mul_f32 v104, s62, v100
    v_mul_f32 v105, s62, v101
    v_mul_f32 v106, s62, v102
    v_mul_f32 v107, s62, v103
    v_exp_f32 v104, v104
    v_exp_f32 v105, v105
    v_exp_f32 v106, v106
    v_exp_f32 v107, v107
    v_add_f32 v104, 1.0, v104
    v_add_f32 v105, 1.0, v105
    v_add_f32 v106, 1.0, v106
    v_add_f32 v107, 1.0, v107
    v_min_f32 v104, 0x7e800000, v104
    v_min_f32 v105, 0x7e800000, v105
    v_min_f32 v106, 0x7e800000, v106
    v_min_f32 v107, 0x7e800000, v107
    v_rcp_f32 v108, v104
    v_rcp_f32 v109, v105
    v_rcp_f32 v110, v106
    v_rcp_f32 v111, v107
    v_mul_f32 v112, v100, v108
    v_mul_f32 v113, v101, v109
    v_mul_f32 v114, v102, v110
    v_mul_f32 v115, v103, v111
    v_fma_f32 v100, -v112, v104, v100
    v_fma_f32 v101, -v113, v105, v101
    v_fma_f32 v102, -v114, v106, v102
    v_fma_f32 v103, -v115, v107, v103
    v_fmac_f32 v112, v100, v108
    v_fmac_f32 v113, v101, v109
    v_fmac_f32 v114, v102, v110
    v_fmac_f32 v115, v103, v111
    v_cvt_pk_bf16_f32 v20, v112, v113
    v_cvt_pk_bf16_f32 v21, v114, v115
    v_lshlrev_b32 v100, 16, v24
    v_and_b32 v101, s60, v24
    v_lshlrev_b32 v102, 16, v25
    v_and_b32 v103, s60, v25
    v_mul_f32 v104, s62, v100
    v_mul_f32 v105, s62, v101
    v_mul_f32 v106, s62, v102
    v_mul_f32 v107, s62, v103
    v_exp_f32 v104, v104
    v_exp_f32 v105, v105
    v_exp_f32 v106, v106
    v_exp_f32 v107, v107
    v_add_f32 v104, 1.0, v104
    v_add_f32 v105, 1.0, v105
    v_add_f32 v106, 1.0, v106
    v_add_f32 v107, 1.0, v107
    v_min_f32 v104, 0x7e800000, v104
    v_min_f32 v105, 0x7e800000, v105
    v_min_f32 v106, 0x7e800000, v106
    v_min_f32 v107, 0x7e800000, v107
    v_rcp_f32 v108, v104
    v_rcp_f32 v109, v105
    v_rcp_f32 v110, v106
    v_rcp_f32 v111, v107
    v_mul_f32 v112, v100, v108
    v_mul_f32 v113, v101, v109
    v_mul_f32 v114, v102, v110
    v_mul_f32 v115, v103, v111
    v_fma_f32 v100, -v112, v104, v100
    v_fma_f32 v101, -v113, v105, v101
    v_fma_f32 v102, -v114, v106, v102
    v_fma_f32 v103, -v115, v107, v103
    v_fmac_f32 v112, v100, v108
    v_fmac_f32 v113, v101, v109
    v_fmac_f32 v114, v102, v110
    v_fmac_f32 v115, v103, v111
    v_cvt_pk_bf16_f32 v24, v112, v113
    v_cvt_pk_bf16_f32 v25, v114, v115
    v_lshlrev_b32 v100, 16, v28
    v_and_b32 v101, s60, v28
    v_lshlrev_b32 v102, 16, v29
    v_and_b32 v103, s60, v29
    v_mul_f32 v104, s62, v100
    v_mul_f32 v105, s62, v101
    v_mul_f32 v106, s62, v102
    v_mul_f32 v107, s62, v103
    v_exp_f32 v104, v104
    v_exp_f32 v105, v105
    v_exp_f32 v106, v106
    v_exp_f32 v107, v107
    v_add_f32 v104, 1.0, v104
    v_add_f32 v105, 1.0, v105
    v_add_f32 v106, 1.0, v106
    v_add_f32 v107, 1.0, v107
    v_min_f32 v104, 0x7e800000, v104
    v_min_f32 v105, 0x7e800000, v105
    v_min_f32 v106, 0x7e800000, v106
    v_min_f32 v107, 0x7e800000, v107
    v_rcp_f32 v108, v104
    v_rcp_f32 v109, v105
    v_rcp_f32 v110, v106
    v_rcp_f32 v111, v107
    v_mul_f32 v112, v100, v108
    v_mul_f32 v113, v101, v109
    v_mul_f32 v114, v102, v110
    v_mul_f32 v115, v103, v111
    v_fma_f32 v100, -v112, v104, v100
    v_fma_f32 v101, -v113, v105, v101
    v_fma_f32 v102, -v114, v106, v102
    v_fma_f32 v103, -v115, v107, v103
    v_fmac_f32 v112, v100, v108
    v_fmac_f32 v113, v101, v109
    v_fmac_f32 v114, v102, v110
    v_fmac_f32 v115, v103, v111
    v_cvt_pk_bf16_f32 v28, v112, v113
    v_cvt_pk_bf16_f32 v29, v114, v115
    v_lshlrev_b32 v100, 16, v32
    v_and_b32 v101, s60, v32
    v_lshlrev_b32 v102, 16, v33
    v_and_b32 v103, s60, v33
    v_mul_f32 v104, s62, v100
    v_mul_f32 v105, s62, v101
    v_mul_f32 v106, s62, v102
    v_mul_f32 v107, s62, v103
    v_exp_f32 v104, v104
    v_exp_f32 v105, v105
    v_exp_f32 v106, v106
    v_exp_f32 v107, v107
    v_add_f32 v104, 1.0, v104
    v_add_f32 v105, 1.0, v105
    v_add_f32 v106, 1.0, v106
    v_add_f32 v107, 1.0, v107
    v_min_f32 v104, 0x7e800000, v104
    v_min_f32 v105, 0x7e800000, v105
    v_min_f32 v106, 0x7e800000, v106
    v_min_f32 v107, 0x7e800000, v107
    v_rcp_f32 v108, v104
    v_rcp_f32 v109, v105
    v_rcp_f32 v110, v106
    v_rcp_f32 v111, v107
    v_mul_f32 v112, v100, v108
    v_mul_f32 v113, v101, v109
    v_mul_f32 v114, v102, v110
    v_mul_f32 v115, v103, v111
    v_fma_f32 v100, -v112, v104, v100
    v_fma_f32 v101, -v113, v105, v101
    v_fma_f32 v102, -v114, v106, v102
    v_fma_f32 v103, -v115, v107, v103
    v_fmac_f32 v112, v100, v108
    v_fmac_f32 v113, v101, v109
    v_fmac_f32 v114, v102, v110
    v_fmac_f32 v115, v103, v111
    v_cvt_pk_bf16_f32 v32, v112, v113
    v_cvt_pk_bf16_f32 v33, v114, v115
    v_mov_b32_dpp v18, v16 row_ror:8 row_mask:0xf bank_mask:0xf
    v_mov_b32_dpp v19, v17 row_ror:8 row_mask:0xf bank_mask:0xf
    v_mov_b32_dpp v22, v20 row_ror:8 row_mask:0xf bank_mask:0xf
    v_mov_b32_dpp v23, v21 row_ror:8 row_mask:0xf bank_mask:0xf
    v_mov_b32_dpp v26, v24 row_ror:8 row_mask:0xf bank_mask:0xf
    v_mov_b32_dpp v27, v25 row_ror:8 row_mask:0xf bank_mask:0xf
    v_mov_b32_dpp v30, v28 row_ror:8 row_mask:0xf bank_mask:0xf
    v_mov_b32_dpp v31, v29 row_ror:8 row_mask:0xf bank_mask:0xf
    v_mov_b32_dpp v34, v32 row_ror:8 row_mask:0xf bank_mask:0xf
    v_mov_b32_dpp v35, v33 row_ror:8 row_mask:0xf bank_mask:0xf
    s_barrier
    ds_read_b64_tr_b16 v[176:177], v168 offset:0
    ds_read_b64_tr_b16 v[178:179], v168 offset:512
    ds_read_b64_tr_b16 v[180:181], v169 offset:0
    ds_read_b64_tr_b16 v[182:183], v169 offset:512
    ds_read_b64_tr_b16 v[184:185], v170 offset:0
    ds_read_b64_tr_b16 v[186:187], v170 offset:512
    ds_read_b64_tr_b16 v[188:189], v171 offset:0
    ds_read_b64_tr_b16 v[190:191], v171 offset:512
    s_waitcnt lgkmcnt(4)
    ds_read_b64_tr_b16 v[192:193], v168 offset:4096
    ds_read_b64_tr_b16 v[194:195], v168 offset:4608
    ds_read_b64_tr_b16 v[196:197], v169 offset:4096
    ds_read_b64_tr_b16 v[198:199], v169 offset:4608
    ds_read_b64_tr_b16 v[200:201], v170 offset:4096
    ds_read_b64_tr_b16 v[202:203], v170 offset:4608
    ds_read_b64_tr_b16 v[204:205], v171 offset:4096
    ds_read_b64_tr_b16 v[206:207], v171 offset:4608
    s_waitcnt lgkmcnt(8)
    v_mfma_f32_16x16x32_bf16 v[40:43], v[176:179], v[16:19], 0
    v_mfma_f32_16x16x32_bf16 v[44:47], v[180:183], v[16:19], 0
    v_mfma_f32_16x16x32_bf16 v[48:51], v[184:187], v[16:19], 0
    v_mfma_f32_16x16x32_bf16 v[52:55], v[188:191], v[16:19], 0
    s_waitcnt lgkmcnt(4)
    ds_read_b64_tr_b16 v[208:209], v168 offset:8192
    ds_read_b64_tr_b16 v[210:211], v168 offset:8704
    ds_read_b64_tr_b16 v[212:213], v169 offset:8192
    ds_read_b64_tr_b16 v[214:215], v169 offset:8704
    ds_read_b64_tr_b16 v[216:217], v170 offset:8192
    ds_read_b64_tr_b16 v[218:219], v170 offset:8704
    ds_read_b64_tr_b16 v[220:221], v171 offset:8192
    ds_read_b64_tr_b16 v[222:223], v171 offset:8704
    s_waitcnt lgkmcnt(8)
    v_mfma_f32_16x16x32_bf16 v[40:43], v[192:195], v[20:23], v[40:43]
    v_mfma_f32_16x16x32_bf16 v[44:47], v[196:199], v[20:23], v[44:47]
    v_mfma_f32_16x16x32_bf16 v[48:51], v[200:203], v[20:23], v[48:51]
    v_mfma_f32_16x16x32_bf16 v[52:55], v[204:207], v[20:23], v[52:55]
    s_waitcnt lgkmcnt(4)
    ds_read_b64_tr_b16 v[224:225], v168 offset:12288
    ds_read_b64_tr_b16 v[226:227], v168 offset:12800
    ds_read_b64_tr_b16 v[228:229], v169 offset:12288
    ds_read_b64_tr_b16 v[230:231], v169 offset:12800
    ds_read_b64_tr_b16 v[232:233], v170 offset:12288
    ds_read_b64_tr_b16 v[234:235], v170 offset:12800
    ds_read_b64_tr_b16 v[236:237], v171 offset:12288
    ds_read_b64_tr_b16 v[238:239], v171 offset:12800
    s_waitcnt lgkmcnt(8)
    v_mfma_f32_16x16x32_bf16 v[40:43], v[208:211], v[24:27], v[40:43]
    v_mfma_f32_16x16x32_bf16 v[44:47], v[212:215], v[24:27], v[44:47]
    v_mfma_f32_16x16x32_bf16 v[48:51], v[216:219], v[24:27], v[48:51]
    v_mfma_f32_16x16x32_bf16 v[52:55], v[220:223], v[24:27], v[52:55]
    s_waitcnt lgkmcnt(4)
    ds_read_b64_tr_b16 v[240:241], v168 offset:16384
    ds_read_b64_tr_b16 v[242:243], v168 offset:16896
    ds_read_b64_tr_b16 v[244:245], v169 offset:16384
    ds_read_b64_tr_b16 v[246:247], v169 offset:16896
    ds_read_b64_tr_b16 v[248:249], v170 offset:16384
    ds_read_b64_tr_b16 v[250:251], v170 offset:16896
    ds_read_b64_tr_b16 v[252:253], v171 offset:16384
    ds_read_b64_tr_b16 v[254:255], v171 offset:16896
    s_waitcnt lgkmcnt(8)
    v_mfma_f32_16x16x32_bf16 v[40:43], v[224:227], v[28:31], v[40:43]
    v_mfma_f32_16x16x32_bf16 v[44:47], v[228:231], v[28:31], v[44:47]
    v_mfma_f32_16x16x32_bf16 v[48:51], v[232:235], v[28:31], v[48:51]
    v_mfma_f32_16x16x32_bf16 v[52:55], v[236:239], v[28:31], v[52:55]
    s_waitcnt lgkmcnt(0)
    v_mfma_f32_16x16x32_bf16 v[40:43], v[240:243], v[32:35], v[40:43]
    v_mfma_f32_16x16x32_bf16 v[44:47], v[244:247], v[32:35], v[44:47]
    v_mfma_f32_16x16x32_bf16 v[48:51], v[248:251], v[32:35], v[48:51]
    v_mfma_f32_16x16x32_bf16 v[52:55], v[252:255], v[32:35], v[52:55]
    s_branch L_wide
L_p2:
    v_lshlrev_b32 v152, 4, v1
    v_lshl_add_u32 v152, s15, 10, v152
    v_add_u32 v153, 4096, v152
    v_add_u32 v154, 8192, v152
    v_add_u32 v155, 12288, v152
    s_cmp_lt_u32 s15, 2
    s_cselect_b32 s72, -1, 0
    v_add_u32 v156, 16384, v152
    v_and_b32 v156, s72, v156
    v_lshlrev_b32 v7, 5, v7
    v_add_u32 v7, 127744, v7
    v_lshl_add_u32 v9, s15, 3, v7
    s_mov_b32 s4, s42
    s_mov_b32 s5, s43
    s_mov_b32 s6, 8388608
    s_mov_b32 s7, 0x20000
    s_load_dword s9, s[42:43], 0
    s_mov_b32 s62, 0xf5555555
    s_mov_b32 s63, 0x2aaaa
    s_mov_b32 s98, 3
    s_bitcmp1_b32 s62, s13
    s_cselect_b32 s98, 0, s98
    s_bitcmp1_b32 s63, s13
    s_cselect_b32 s98, 1, s98
    s_bfm_b32 s64, s13, 0
    s_and_b32 s63, s63, s64
    s_bcnt1_i32_b32 s77, s63
    s_and_b32 s62, s62, s64
    s_bcnt1_i32_b32 s62, s62
    s_mul_i32 s14, s12, 18
    s_add_u32 s14, s14, s62
    s_waitcnt lgkmcnt(0)
    s_add_u32 s9, s9, 0x9e3779b9
    s_and_b32 s8, s9, 0xbfffbfff
    s_mov_b32 s76, 0
    s_cmp_lg_u32 s15, 3
    s_cbranch_scc1 L_xc_16
    s_getreg_b32 s62, hwreg(HW_REG_XCC_ID)
    s_lshl_b32 s63, s12, 5
    s_add_u32 s63, s63, s13
    s_lshl_b32 s63, s63, 3
    s_add_u32 s63, s63, 65536
    v_mov_b32 v12, s62
    v_mov_b32 v13, s8
    s_mov_b64 exec, 1
    buffer_store_dwordx2 v[12:13], off, s[4:7], s63
    s_mov_b64 exec, -1
L_xc_16:
    s_lshl_b32 s78, s100, 11
    s_add_u32 s78, s78, 262144
    v_lshrrev_b32 v5, 2, v3
    v_lshl_add_u32 v6, v2, 3, v5
    v_lshlrev_b32 v6, 7, v6
    v_and_b32 v5, 3, v3
    v_lshl_add_u32 v6, v5, 3, v6
    v_bfe_u32 v5, v1, 3, 2
    v_lshl_add_u32 v6, v5, 5, v6
    v_xor_b32 v168, 0, v6
    v_add_u32 v168, s101, v168
    v_xor_b32 v169, 32, v6
    v_add_u32 v169, s101, v169
    v_xor_b32 v170, 64, v6
    v_add_u32 v170, s101, v170
    v_xor_b32 v171, 96, v6
    v_add_u32 v171, s101, v171
    v_and_b32 v14, 7, v3
    v_mul_u32_u24 v14, 272, v14
    v_lshl_add_u32 v14, v2, 4, v14
    s_mul_i32 s62, s15, 2176
    s_add_u32 s62, s62, 118784
    v_add_u32 v14, s62, v14
    v_and_b32 v5, 1, v2
    v_lshl_add_u32 v5, s15, 1, v5
    v_mul_u32_u24 v15, 272, v5
    v_lshl_add_u32 v15, v3, 4, v15
    v_add_u32 v15, 118784, v15
    v_mul_u32_u24 v5, 256, v5
    v_lshl_add_u32 v5, v3, 4, v5
    v_mov_b32 v37, s8
    v_mov_b32 v39, s8
    s_mov_b32 s68, 0xff00ff
    s_mov_b32 s69, 0xff00ff
    s_cmp_lt_u32 s15, 2
    s_cselect_b32 s72, 1.0, 0
    s_waitcnt vmcnt(0)
    v_and_b32 v6, 7, v1
    v_lshlrev_b32 v6, 5, v6
    v_lshrrev_b32 v8, 3, v1
    v_lshl_add_u32 v6, v8, 2, v6
    ds_bpermute_b32 v16, v6, v16
    ds_bpermute_b32 v17, v6, v17
    ds_bpermute_b32 v20, v6, v20
    ds_bpermute_b32 v21, v6, v21
    ds_bpermute_b32 v24, v6, v24
    ds_bpermute_b32 v25, v6, v25
    ds_bpermute_b32 v28, v6, v28
    ds_bpermute_b32 v29, v6, v29
    ds_bpermute_b32 v32, v6, v32
    ds_bpermute_b32 v33, v6, v33
    ds_bpermute_b32 v36, v6, v36
    s_waitcnt lgkmcnt(0)
    v_lshlrev_b32 v8, 16, v36
    v_lshlrev_b32 v132, 16, v16
    v_and_b32 v133, s60, v16
    v_lshlrev_b32 v134, 16, v17
    v_and_b32 v135, s60, v17
    v_lshlrev_b32 v136, 16, v20
    v_and_b32 v137, s60, v20
    v_lshlrev_b32 v138, 16, v21
    v_and_b32 v139, s60, v21
    v_lshlrev_b32 v140, 16, v24
    v_and_b32 v141, s60, v24
    v_lshlrev_b32 v142, 16, v25
    v_and_b32 v143, s60, v25
    v_lshlrev_b32 v144, 16, v28
    v_and_b32 v145, s60, v28
    v_lshlrev_b32 v146, 16, v29
    v_and_b32 v147, s60, v29
    v_lshlrev_b32 v148, 16, v32
    v_and_b32 v149, s60, v32
    v_lshlrev_b32 v150, 16, v33
    v_and_b32 v151, s60, v33
    v_sub_f32 v100, v148, v8
    v_sub_f32 v101, v149, v8
    v_sub_f32 v102, v150, v8
    v_sub_f32 v103, v151, v8
    v_add_f32 v10, v100, v101
    v_mul_f32 v11, v100, v100
    v_add_f32 v10, v10, v102
    v_fmac_f32 v11, v101, v101
    v_add_f32 v10, v10, v103
    v_fmac_f32 v11, v102, v102
    v_mul_f32 v10, s72, v10
    v_fmac_f32 v11, v103, v103
    v_mul_f32 v11, s72, v11
    v_sub_f32 v100, v132, v8
    v_sub_f32 v101, v133, v8
    v_sub_f32 v102, v134, v8
    v_sub_f32 v103, v135, v8
    v_sub_f32 v104, v136, v8
    v_sub_f32 v105, v137, v8
    v_sub_f32 v106, v138, v8
    v_sub_f32 v107, v139, v8
    v_sub_f32 v108, v140, v8
    v_sub_f32 v109, v141, v8
    v_sub_f32 v110, v142, v8
    v_sub_f32 v111, v143, v8
    v_sub_f32 v112, v144, v8
    v_sub_f32 v113, v145, v8
    v_sub_f32 v114, v146, v8
    v_sub_f32 v115, v147, v8
    v_add_f32 v10, v10, v100
    v_fmac_f32 v11, v100, v100
    v_add_f32 v10, v10, v101
    v_fmac_f32 v11, v101, v101
    v_add_f32 v10, v10, v102
    v_fmac_f32 v11, v102, v102
    v_add_f32 v10, v10, v103
    v_fmac_f32 v11, v103, v103
    v_add_f32 v10, v10, v104
    v_fmac_f32 v11, v104, v104
    v_add_f32 v10, v10, v105
    v_fmac_f32 v11, v105, v105
    v_add_f32 v10, v10, v106
    v_fmac_f32 v11, v106, v106
    v_add_f32 v10, v10, v107
    v_fmac_f32 v11, v107, v107
    v_add_f32 v10, v10, v108
    v_fmac_f32 v11, v108, v108
    v_add_f32 v10, v10, v109
    v_fmac_f32 v11, v109, v109
    v_add_f32 v10, v10, v110
    v_fmac_f32 v11, v110, v110
    v_add_f32 v10, v10, v111
    v_fmac_f32 v11, v111, v111
    v_add_f32 v10, v10, v112
    v_fmac_f32 v11, v112, v112
    v_add_f32 v10, v10, v113
    v_fmac_f32 v11, v113, v113
    v_add_f32 v10, v10, v114
    v_fmac_f32 v11, v114, v114
    v_add_f32 v10, v10, v115
    v_fmac_f32 v11, v115, v115
    s_nop 0
    v_add_f32_dpp v10, v10, v10 row_ror:8 row_mask:0xf bank_mask:0xf
    v_add_f32_dpp v11, v11, v11 row_ror:8 row_mask:0xf bank_mask:0xf
    v_mov_b32 v12, v10
    s_nop 1
    v_permlane16_swap_b32 v10, v12
    v_add_f32 v10, v10, v12
    v_mov_b32 v12, v10
    s_nop 1
    v_permlane32_swap_b32 v10, v12
    v_add_f32 v10, v10, v12
    v_mov_b32 v12, v11
    s_nop 1
    v_permlane16_swap_b32 v11, v12
    v_add_f32 v11, v11, v12
    v_mov_b32 v12, v11
    s_nop 1
    v_permlane32_swap_b32 v11, v12
    v_add_f32 v11, v11, v12
    ds_write_b64 v9, v[10:11]
    s_mov_b32 s62, 131072
    s_mov_b32 s63, 149504
    s_waitcnt lgkmcnt(0)
    s_barrier
    ds_read_b128 v[100:103], v7
    ds_read_b128 v[104:107], v7 offset:16
    ds_read_b64_tr_b16 v[176:177], v168 offset:0
    ds_read_b64_tr_b16 v[178:179], v168 offset:512
    ds_read_b64_tr_b16 v[180:181], v169 offset:0
    ds_read_b64_tr_b16 v[182:183], v169 offset:512
    ds_read_b64_tr_b16 v[184:185], v170 offset:0
    ds_read_b64_tr_b16 v[186:187], v170 offset:512
    ds_read_b64_tr_b16 v[188:189], v171 offset:0
    ds_read_b64_tr_b16 v[190:191], v171 offset:512
    s_waitcnt lgkmcnt(4)
    ds_read_b64_tr_b16 v[192:193], v168 offset:4096
    ds_read_b64_tr_b16 v[194:195], v168 offset:4608
    ds_read_b64_tr_b16 v[196:197], v169 offset:4096
    ds_read_b64_tr_b16 v[198:199], v169 offset:4608
    ds_read_b64_tr_b16 v[200:201], v170 offset:4096
    ds_read_b64_tr_b16 v[202:203], v170 offset:4608
    ds_read_b64_tr_b16 v[204:205], v171 offset:4096
    ds_read_b64_tr_b16 v[206:207], v171 offset:4608
    s_waitcnt lgkmcnt(4)
    ds_read_b64_tr_b16 v[208:209], v168 offset:8192
    ds_read_b64_tr_b16 v[210:211], v168 offset:8704
    ds_read_b64_tr_b16 v[212:213], v169 offset:8192
    ds_read_b64_tr_b16 v[214:215], v169 offset:8704
    ds_read_b64_tr_b16 v[216:217], v170 offset:8192
    ds_read_b64_tr_b16 v[218:219], v170 offset:8704
    ds_read_b64_tr_b16 v[220:221], v171 offset:8192
    ds_read_b64_tr_b16 v[222:223], v171 offset:8704
    s_waitcnt lgkmcnt(4)
    ds_read_b64_tr_b16 v[224:225], v168 offset:12288
    ds_read_b64_tr_b16 v[226:227], v168 offset:12800
    ds_read_b64_tr_b16 v[228:229], v169 offset:12288
    ds_read_b64_tr_b16 v[230:231], v169 offset:12800
    ds_read_b64_tr_b16 v[232:233], v170 offset:12288
    ds_read_b64_tr_b16 v[234:235], v170 offset:12800
    ds_read_b64_tr_b16 v[236:237], v171 offset:12288
    ds_read_b64_tr_b16 v[238:239], v171 offset:12800
    s_waitcnt lgkmcnt(4)
    ds_read_b64_tr_b16 v[240:241], v168 offset:16384
    ds_read_b64_tr_b16 v[242:243], v168 offset:16896
    ds_read_b64_tr_b16 v[244:245], v169 offset:16384
    ds_read_b64_tr_b16 v[246:247], v169 offset:16896
    ds_read_b64_tr_b16 v[248:249], v170 offset:16384
    ds_read_b64_tr_b16 v[250:251], v170 offset:16896
    ds_read_b64_tr_b16 v[252:253], v171 offset:16384
    ds_read_b64_tr_b16 v[254:255], v171 offset:16896
    s_waitcnt lgkmcnt(0)
    v_add_f32 v10, v100, v102
    v_add_f32 v11, v101, v103
    v_add_f32 v12, v104, v106
    v_add_f32 v13, v105, v107
    v_add_f32 v10, v10, v12
    v_add_f32 v11, v11, v13
    v_mul_f32 v10, 0x3ae38e39, v10
    v_mul_f32 v11, 0x3ae38e39, v11
    v_fma_f32 v11, -v10, v10, v11
    v_add_f32 v10, v10, v8
    v_max_f32 v11, 0, v11
    s_cmp_lg_u32 s98, 1
    s_cbranch_scc1 L_nowh
    s_mov_b32 s48, s24
    s_mov_b32 s49, s25
    s_mov_b32 s50, 4718592
    s_mov_b32 s51, 0x20000
    v_lshrrev_b32 v8, 3, v1
    v_mul_u32_u24 v8, 1152, v8
    v_and_b32 v9, 7, v1
    v_lshl_add_u32 v8, v9, 4, v8
    s_lshl_b32 s72, s12, 2
    s_add_u32 s72, s72, s15
    s_mul_i32 s72, s72, 147456
    s_lshl_b32 s73, s77, 7
    s_add_u32 s72, s72, s73
    s_add_u32 m0, s101, 0
    s_nop 0
    buffer_load_dwordx4 v8, s[48:51], s72 offen nt lds
    s_add_u32 s72, s72, 9216
    s_add_u32 m0, s101, 1024
    s_nop 0
    buffer_load_dwordx4 v8, s[48:51], s72 offen nt lds
    s_add_u32 s72, s72, 9216
    s_add_u32 m0, s101, 2048
    s_nop 0
    buffer_load_dwordx4 v8, s[48:51], s72 offen nt lds
    s_add_u32 s72, s72, 9216
    s_add_u32 m0, s101, 3072
    s_nop 0
    buffer_load_dwordx4 v8, s[48:51], s72 offen nt lds
    s_add_u32 s72, s72, 9216
    s_add_u32 m0, s101, 4096
    s_nop 0
    buffer_load_dwordx4 v8, s[48:51], s72 offen nt lds
    s_add_u32 s72, s72, 9216
    s_add_u32 m0, s101, 5120
    s_nop 0
    buffer_load_dwordx4 v8, s[48:51], s72 offen nt lds
    s_add_u32 s72, s72, 9216
    s_add_u32 m0, s101, 6144
    s_nop 0
    buffer_load_dwordx4 v8, s[48:51], s72 offen nt lds
    s_add_u32 s72, s72, 9216
    s_add_u32 m0, s101, 7168
    s_nop 0
    buffer_load_dwordx4 v8, s[48:51], s72 offen nt lds
    s_add_u32 s72, s72, 9216
    s_add_u32 m0, s101, 8192
    s_nop 0
    buffer_load_dwordx4 v8, s[48:51], s72 offen nt lds
    s_add_u32 s72, s72, 9216
    s_add_u32 m0, s101, 9216
    s_nop 0
    buffer_load_dwordx4 v8, s[48:51], s72 offen nt lds
    s_add_u32 s72, s72, 9216
    s_add_u32 m0, s101, 10240
    s_nop 0
    buffer_load_dwordx4 v8, s[48:51], s72 offen nt lds
    s_add_u32 s72, s72, 9216
    s_add_u32 m0, s101, 11264
    s_nop 0
    buffer_load_dwordx4 v8, s[48:51], s72 offen nt lds
    s_add_u32 s72, s72, 9216
    s_add_u32 m0, s101, 12288
    s_nop 0
    buffer_load_dwordx4 v8, s[48:51], s72 offen nt lds
    s_add_u32 s72, s72, 9216
    s_add_u32 m0, s101, 13312
    s_nop 0
    buffer_load_dwordx4 v8, s[48:51], s72 offen nt lds
    s_add_u32 s72, s72, 9216
    s_add_u32 m0, s101, 14336
    s_nop 0
    buffer_load_dwordx4 v8, s[48:51], s72 offen nt lds
    s_add_u32 s72, s72, 9216
    s_add_u32 m0, s101, 15360
    s_nop 0
    buffer_load_dwordx4 v8, s[48:51], s72 offen nt lds
L_nowh:
    v_cvt_pk_bf16_f32 v12, v10, v11
    v_lshlrev_b32 v10, 16, v12
    v_and_b32 v11, s60, v12
    v_add_f32 v11, 0x3727c5ac, v11
    v_cvt_pk_bf16_f32 v12, v11, v11
    v_and_b32 v11, s60, v12
    v_sqrt_f32 v11, v11
    s_nop 0
    v_cvt_pk_bf16_f32 v12, v11, v11
    v_and_b32 v11, s60, v12
    v_rcp_f32 v11, v11
    v_sub_f32 v132, v132, v10
    v_sub_f32 v133, v133, v10
    v_sub_f32 v134, v134, v10
    v_sub_f32 v135, v135, v10
    v_cvt_pk_bf16_f32 v12, v132, v133
    v_cvt_pk_bf16_f32 v13, v134, v135
    v_lshlrev_b32 v132, 16, v12
    v_and_b32 v133, s60, v12
    v_lshlrev_b32 v134, 16, v13
    v_and_b32 v135, s60, v13
    v_mul_f32 v132, v132, v11
    v_mul_f32 v133, v133, v11
    v_mul_f32 v134, v134, v11
    v_mul_f32 v135, v135, v11
    v_cvt_pk_bf16_f32 v12, v132, v133
    v_cvt_pk_bf16_f32 v13, v134, v135
    v_lshlrev_b32 v132, 16, v12
    v_and_b32 v133, s60, v12
    v_lshlrev_b32 v134, 16, v13
    v_and_b32 v135, s60, v13
    v_sub_f32 v136, v136, v10
    v_sub_f32 v137, v137, v10
    v_sub_f32 v138, v138, v10
    v_sub_f32 v139, v139, v10
    v_cvt_pk_bf16_f32 v12, v136, v137
    v_cvt_pk_bf16_f32 v13, v138, v139
    v_lshlrev_b32 v136, 16, v12
    v_and_b32 v137, s60, v12
    v_lshlrev_b32 v138, 16, v13
    v_and_b32 v139, s60, v13
    v_mul_f32 v136, v136, v11
    v_mul_f32 v137, v137, v11
    v_mul_f32 v138, v138, v11
    v_mul_f32 v139, v139, v11
    v_cvt_pk_bf16_f32 v12, v136, v137
    v_cvt_pk_bf16_f32 v13, v138, v139
    v_lshlrev_b32 v136, 16, v12
    v_and_b32 v137, s60, v12
    v_lshlrev_b32 v138, 16, v13
    v_and_b32 v139, s60, v13
    v_sub_f32 v140, v140, v10
    v_sub_f32 v141, v141, v10
    v_sub_f32 v142, v142, v10
    v_sub_f32 v143, v143, v10
    v_cvt_pk_bf16_f32 v12, v140, v141
    v_cvt_pk_bf16_f32 v13, v142, v143
    v_lshlrev_b32 v140, 16, v12
    v_and_b32 v141, s60, v12
    v_lshlrev_b32 v142, 16, v13
    v_and_b32 v143, s60, v13
    v_mul_f32 v140, v140, v11
    v_mul_f32 v141, v141, v11
    v_mul_f32 v142, v142, v11
    v_mul_f32 v143, v143, v11
    v_cvt_pk_bf16_f32 v12, v140, v141
    v_cvt_pk_bf16_f32 v13, v142, v143
    v_lshlrev_b32 v140, 16, v12
    v_and_b32 v141, s60, v12
    v_lshlrev_b32 v142, 16, v13
    v_and_b32 v143, s60, v13
    v_sub_f32 v144, v144, v10
    v_sub_f32 v145, v145, v10
    v_sub_f32 v146, v146, v10
    v_sub_f32 v147, v147, v10
    v_cvt_pk_bf16_f32 v12, v144, v145
    v_cvt_pk_bf16_f32 v13, v146, v147
    v_lshlrev_b32 v144, 16, v12
    v_and_b32 v145, s60, v12
    v_lshlrev_b32 v146, 16, v13
    v_and_b32 v147, s60, v13
    v_mul_f32 v144, v144, v11
    v_mul_f32 v145, v145, v11
    v_mul_f32 v146, v146, v11
    v_mul_f32 v147, v147, v11
    v_cvt_pk_bf16_f32 v12, v144, v145
    v_cvt_pk_bf16_f32 v13, v146, v147
    v_lshlrev_b32 v144, 16, v12
    v_and_b32 v145, s60, v12
    v_lshlrev_b32 v146, 16, v13
    v_and_b32 v147, s60, v13
    v_sub_f32 v148, v148, v10
    v_sub_f32 v149, v149, v10
    v_sub_f32 v150, v150, v10
    v_sub_f32 v151, v151, v10
    v_cvt_pk_bf16_f32 v12, v148, v149
    v_cvt_pk_bf16_f32 v13, v150, v151
    v_lshlrev_b32 v148, 16, v12
    v_and_b32 v149, s60, v12
    v_lshlrev_b32 v150, 16, v13
    v_and_b32 v151, s60, v13
    v_mul_f32 v148, v148, v11
    v_mul_f32 v149, v149, v11
    v_mul_f32 v150, v150, v11
    v_mul_f32 v151, v151, v11
    v_cvt_pk_bf16_f32 v12, v148, v149
    v_cvt_pk_bf16_f32 v13, v150, v151
    v_lshlrev_b32 v148, 16, v12
    v_and_b32 v149, s60, v12
    v_lshlrev_b32 v150, 16, v13
    v_and_b32 v151, s60, v13
    v_and_b32 v98, 31, v1
    v_lshlrev_b32 v98, 3, v98
    s_lshl_b32 s22, s12, 8
    s_add_u32 s22, s22, 65536
    buffer_load_dwordx2 v[96:97], v98, s[4:7], s22 offen sc1
L_hpoll:
    buffer_load_dwordx4 v[76:79], v152, s[4:7], s63 offen offset:0 sc1
    buffer_load_dwordx4 v[80:83], v153, s[4:7], s63 offen offset:0 sc1
    buffer_load_dwordx4 v[84:87], v154, s[4:7], s63 offen offset:0 sc1
    buffer_load_dwordx4 v[88:91], v155, s[4:7], s63 offen offset:0 sc1
    buffer_load_dwordx4 v[92:95], v156, s[4:7], s63 offen offset:0 sc1
    buffer_load_dwordx4 v[56:59], v152, s[4:7], s62 offen offset:0 sc1
    buffer_load_dwordx4 v[60:63], v153, s[4:7], s62 offen offset:0 sc1
    buffer_load_dwordx4 v[64:67], v154, s[4:7], s62 offen offset:0 sc1
    buffer_load_dwordx4 v[68:71], v155, s[4:7], s62 offen offset:0 sc1
    buffer_load_dwordx4 v[72:75], v156, s[4:7], s62 offen offset:0 sc1
    s_waitcnt vmcnt(0)
    v_bitop3_b32 v12, v57, v59, s8 bitop3:0x7e
    v_bitop3_b32 v10, v61, v63, s8 bitop3:0x7e
    v_bitop3_b32 v11, v65, v67, s8 bitop3:0x7e
    v_or3_b32 v12, v12, v10, v11
    v_bitop3_b32 v10, v69, v71, s8 bitop3:0x7e
    v_bitop3_b32 v11, v73, v75, s8 bitop3:0x7e
    v_or3_b32 v12, v12, v10, v11
    v_bitop3_b32 v10, v77, v79, s8 bitop3:0x7e
    v_bitop3_b32 v11, v81, v83, s8 bitop3:0x7e
    v_or3_b32 v12, v12, v10, v11
    v_bitop3_b32 v10, v85, v87, s8 bitop3:0x7e
    v_bitop3_b32 v11, v89, v91, s8 bitop3:0x7e
    v_or3_b32 v12, v12, v10, v11
    v_bitop3_b32 v10, v93, v95, s8 bitop3:0x7e
    v_or_b32 v12, v12, v10
    v_cmp_ne_u32 vcc, 0, v12
    s_nop 0
    s_cbranch_vccz L_hpollok
    s_mov_b64 exec, vcc
    s_sleep 1
    s_sub_u32 s66, s66, 1
    s_cmp_lg_u32 s66, 0
    s_cbranch_scc1 L_hpoll
    s_branch L_exit
L_hpollok:
    s_mov_b64 exec, -1
    s_getreg_b32 s22, hwreg(HW_REG_XCC_ID)
    v_xor_b32 v96, s22, v96
    v_xor_b32 v97, s8, v97
    v_or_b32 v96, v96, v97
    v_cmp_ne_u32 vcc, 0, v96
    s_nop 0
    s_cmp_eq_u64 vcc, 0
    s_cselect_b32 s76, 1, 0
    v_lshlrev_b32 v100, 16, v76
    v_and_b32 v101, s60, v76
    v_lshlrev_b32 v102, 16, v78
    v_and_b32 v103, s60, v78
    v_lshlrev_b32 v104, 16, v56
    v_and_b32 v105, s60, v56
    v_lshlrev_b32 v106, 16, v58
    v_and_b32 v107, s60, v58
    v_add_f32 v100, 1.0, v100
    v_add_f32 v101, 1.0, v101
    v_add_f32 v102, 1.0, v102
    v_add_f32 v103, 1.0, v103
    v_cvt_pk_bf16_f32 v12, v100, v101
    v_cvt_pk_bf16_f32 v13, v102, v103
    v_lshlrev_b32 v100, 16, v12
    v_and_b32 v101, s60, v12
    v_lshlrev_b32 v102, 16, v13
    v_and_b32 v103, s60, v13
    v_mul_f32 v132, v132, v100
    v_mul_f32 v133, v133, v101
    v_mul_f32 v134, v134, v102
    v_mul_f32 v135, v135, v103
    v_cvt_pk_bf16_f32 v12, v132, v133
    v_cvt_pk_bf16_f32 v13, v134, v135
    v_lshlrev_b32 v132, 16, v12
    v_and_b32 v133, s60, v12
    v_lshlrev_b32 v134, 16, v13
    v_and_b32 v135, s60, v13
    v_add_f32 v132, v132, v104
    v_add_f32 v133, v133, v105
    v_add_f32 v134, v134, v106
    v_add_f32 v135, v135, v107
    v_cvt_pk_bf16_f32 v16, v132, v133
    v_cvt_pk_bf16_f32 v17, v134, v135
    v_lshlrev_b32 v100, 16, v80
    v_and_b32 v101, s60, v80
    v_lshlrev_b32 v102, 16, v82
    v_and_b32 v103, s60, v82
    v_lshlrev_b32 v104, 16, v60
    v_and_b32 v105, s60, v60
    v_lshlrev_b32 v106, 16, v62
    v_and_b32 v107, s60, v62
    v_add_f32 v100, 1.0, v100
    v_add_f32 v101, 1.0, v101
    v_add_f32 v102, 1.0, v102
    v_add_f32 v103, 1.0, v103
    v_cvt_pk_bf16_f32 v12, v100, v101
    v_cvt_pk_bf16_f32 v13, v102, v103
    v_lshlrev_b32 v100, 16, v12
    v_and_b32 v101, s60, v12
    v_lshlrev_b32 v102, 16, v13
    v_and_b32 v103, s60, v13
    v_mul_f32 v136, v136, v100
    v_mul_f32 v137, v137, v101
    v_mul_f32 v138, v138, v102
    v_mul_f32 v139, v139, v103
    v_cvt_pk_bf16_f32 v12, v136, v137
    v_cvt_pk_bf16_f32 v13, v138, v139
    v_lshlrev_b32 v136, 16, v12
    v_and_b32 v137, s60, v12
    v_lshlrev_b32 v138, 16, v13
    v_and_b32 v139, s60, v13
    v_add_f32 v136, v136, v104
    v_add_f32 v137, v137, v105
    v_add_f32 v138, v138, v106
    v_add_f32 v139, v139, v107
    v_cvt_pk_bf16_f32 v20, v136, v137
    v_cvt_pk_bf16_f32 v21, v138, v139
    v_mov_b32_dpp v18, v16 row_ror:8 row_mask:0xf bank_mask:0xf
    v_mov_b32_dpp v19, v17 row_ror:8 row_mask:0xf bank_mask:0xf
    v_lshlrev_b32 v100, 16, v84
    v_and_b32 v101, s60, v84
    v_lshlrev_b32 v102, 16, v86
    v_and_b32 v103, s60, v86
    v_lshlrev_b32 v104, 16, v64
    v_and_b32 v105, s60, v64
    v_lshlrev_b32 v106, 16, v66
    v_and_b32 v107, s60, v66
    v_add_f32 v100, 1.0, v100
    v_add_f32 v101, 1.0, v101
    v_add_f32 v102, 1.0, v102
    v_add_f32 v103, 1.0, v103
    v_cvt_pk_bf16_f32 v12, v100, v101
    v_cvt_pk_bf16_f32 v13, v102, v103
    v_lshlrev_b32 v100, 16, v12
    v_and_b32 v101, s60, v12
    v_lshlrev_b32 v102, 16, v13
    v_and_b32 v103, s60, v13
    v_mul_f32 v140, v140, v100
    v_mul_f32 v141, v141, v101
    v_mul_f32 v142, v142, v102
    v_mul_f32 v143, v143, v103
    v_cvt_pk_bf16_f32 v12, v140, v141
    v_cvt_pk_bf16_f32 v13, v142, v143
    v_lshlrev_b32 v140, 16, v12
    v_and_b32 v141, s60, v12
    v_lshlrev_b32 v142, 16, v13
    v_and_b32 v143, s60, v13
    v_add_f32 v140, v140, v104
    v_add_f32 v141, v141, v105
    v_add_f32 v142, v142, v106
    v_add_f32 v143, v143, v107
    v_cvt_pk_bf16_f32 v24, v140, v141
    v_cvt_pk_bf16_f32 v25, v142, v143
    v_mov_b32_dpp v22, v20 row_ror:8 row_mask:0xf bank_mask:0xf
    v_mov_b32_dpp v23, v21 row_ror:8 row_mask:0xf bank_mask:0xf
    v_mfma_f32_16x16x32_bf16 v[40:43], v[176:179], v[16:19], 0
    v_mfma_f32_16x16x32_bf16 v[44:47], v[180:183], v[16:19], 0
    v_mfma_f32_16x16x32_bf16 v[48:51], v[184:187], v[16:19], 0
    v_mfma_f32_16x16x32_bf16 v[52:55], v[188:191], v[16:19], 0
    v_lshlrev_b32 v100, 16, v88
    v_and_b32 v101, s60, v88
    v_lshlrev_b32 v102, 16, v90
    v_and_b32 v103, s60, v90
    v_lshlrev_b32 v104, 16, v68
    v_and_b32 v105, s60, v68
    v_lshlrev_b32 v106, 16, v70
    v_and_b32 v107, s60, v70
    v_add_f32 v100, 1.0, v100
    v_add_f32 v101, 1.0, v101
    v_add_f32 v102, 1.0, v102
    v_add_f32 v103, 1.0, v103
    v_cvt_pk_bf16_f32 v12, v100, v101
    v_cvt_pk_bf16_f32 v13, v102, v103
    v_lshlrev_b32 v100, 16, v12
    v_and_b32 v101, s60, v12
    v_lshlrev_b32 v102, 16, v13
    v_and_b32 v103, s60, v13
    v_mul_f32 v144, v144, v100
    v_mul_f32 v145, v145, v101
    v_mul_f32 v146, v146, v102
    v_mul_f32 v147, v147, v103
    v_cvt_pk_bf16_f32 v12, v144, v145
    v_cvt_pk_bf16_f32 v13, v146, v147
    v_lshlrev_b32 v144, 16, v12
    v_and_b32 v145, s60, v12
    v_lshlrev_b32 v146, 16, v13
    v_and_b32 v147, s60, v13
    v_add_f32 v144, v144, v104
    v_add_f32 v145, v145, v105
    v_add_f32 v146, v146, v106
    v_add_f32 v147, v147, v107
    v_cvt_pk_bf16_f32 v28, v144, v145
    v_cvt_pk_bf16_f32 v29, v146, v147
    v_mov_b32_dpp v26, v24 row_ror:8 row_mask:0xf bank_mask:0xf
    v_mov_b32_dpp v27, v25 row_ror:8 row_mask:0xf bank_mask:0xf
    v_mfma_f32_16x16x32_bf16 v[40:43], v[192:195], v[20:23], v[40:43]
    v_mfma_f32_16x16x32_bf16 v[44:47], v[196:199], v[20:23], v[44:47]
    v_mfma_f32_16x16x32_bf16 v[48:51], v[200:203], v[20:23], v[48:51]
    v_mfma_f32_16x16x32_bf16 v[52:55], v[204:207], v[20:23], v[52:55]
    v_lshlrev_b32 v100, 16, v92
    v_and_b32 v101, s60, v92
    v_lshlrev_b32 v102, 16, v94
    v_and_b32 v103, s60, v94
    v_lshlrev_b32 v104, 16, v72
    v_and_b32 v105, s60, v72
    v_lshlrev_b32 v106, 16, v74
    v_and_b32 v107, s60, v74
    v_add_f32 v100, 1.0, v100
    v_add_f32 v101, 1.0, v101
    v_add_f32 v102, 1.0, v102
    v_add_f32 v103, 1.0, v103
    v_cvt_pk_bf16_f32 v12, v100, v101
    v_cvt_pk_bf16_f32 v13, v102, v103
    v_lshlrev_b32 v100, 16, v12
    v_and_b32 v101, s60, v12
    v_lshlrev_b32 v102, 16, v13
    v_and_b32 v103, s60, v13
    v_mul_f32 v148, v148, v100
    v_mul_f32 v149, v149, v101
    v_mul_f32 v150, v150, v102
    v_mul_f32 v151, v151, v103
    v_cvt_pk_bf16_f32 v12, v148, v149
    v_cvt_pk_bf16_f32 v13, v150, v151
    v_lshlrev_b32 v148, 16, v12
    v_and_b32 v149, s60, v12
    v_lshlrev_b32 v150, 16, v13
    v_and_b32 v151, s60, v13
    v_add_f32 v148, v148, v104
    v_add_f32 v149, v149, v105
    v_add_f32 v150, v150, v106
    v_add_f32 v151, v151, v107
    v_cvt_pk_bf16_f32 v32, v148, v149
    v_cvt_pk_bf16_f32 v33, v150, v151
    v_mov_b32_dpp v30, v28 row_ror:8 row_mask:0xf bank_mask:0xf
    v_mov_b32_dpp v31, v29 row_ror:8 row_mask:0xf bank_mask:0xf
    v_mfma_f32_16x16x32_bf16 v[40:43], v[208:211], v[24:27], v[40:43]
    v_mfma_f32_16x16x32_bf16 v[44:47], v[212:215], v[24:27], v[44:47]
    v_mfma_f32_16x16x32_bf16 v[48:51], v[216:219], v[24:27], v[48:51]
    v_mfma_f32_16x16x32_bf16 v[52:55], v[220:223], v[24:27], v[52:55]
    v_mov_b32_dpp v34, v32 row_ror:8 row_mask:0xf bank_mask:0xf
    v_mov_b32_dpp v35, v33 row_ror:8 row_mask:0xf bank_mask:0xf
    v_mfma_f32_16x16x32_bf16 v[40:43], v[224:227], v[28:31], v[40:43]
    v_mfma_f32_16x16x32_bf16 v[44:47], v[228:231], v[28:31], v[44:47]
    v_mfma_f32_16x16x32_bf16 v[48:51], v[232:235], v[28:31], v[48:51]
    v_mfma_f32_16x16x32_bf16 v[52:55], v[236:239], v[28:31], v[52:55]
    v_mfma_f32_16x16x32_bf16 v[40:43], v[240:243], v[32:35], v[40:43]
    v_mfma_f32_16x16x32_bf16 v[44:47], v[244:247], v[32:35], v[44:47]
    v_mfma_f32_16x16x32_bf16 v[48:51], v[248:251], v[32:35], v[48:51]
    v_mfma_f32_16x16x32_bf16 v[52:55], v[252:255], v[32:35], v[52:55]
L_wide:
    s_mov_b64 exec, s[68:69]
    s_nop 3
    ds_write_b128 v14, v[40:43] offset:0
    ds_write_b128 v14, v[44:47] offset:64
    ds_write_b128 v14, v[48:51] offset:128
    ds_write_b128 v14, v[52:55] offset:192
    s_mov_b64 exec, -1
    s_waitcnt lgkmcnt(0)
    s_barrier
    ds_read_b128 v[100:103], v15 offset:0
    ds_read_b128 v[104:107], v15 offset:2176
    ds_read_b128 v[108:111], v15 offset:4352
    ds_read_b128 v[112:115], v15 offset:6528
    s_waitcnt lgkmcnt(0)
    v_add_f32 v100, v100, v104
    v_add_f32 v108, v108, v112
    v_add_f32 v101, v101, v105
    v_add_f32 v109, v109, v113
    v_add_f32 v102, v102, v106
    v_add_f32 v110, v110, v114
    v_add_f32 v103, v103, v107
    v_add_f32 v111, v111, v115
    v_add_f32 v100, v100, v108
    v_add_f32 v101, v101, v109
    v_add_f32 v102, v102, v110
    v_add_f32 v103, v103, v111
    v_cvt_pk_bf16_f32 v36, v100, v101
    v_cvt_pk_bf16_f32 v38, v102, v103
    s_mov_b32 exec_hi, 0
    s_cmp_eq_u32 s76, 1
    s_cbranch_scc1 L_st_17a
    buffer_store_dwordx4 v[36:39], v5, s[4:7], s78 offen sc1
    s_branch L_st_17b
L_st_17a:
    buffer_store_dwordx4 v[36:39], v5, s[4:7], s78 offen
L_st_17b:
    s_mov_b64 exec, -1
    s_barrier
L_pdone:
    s_cmp_lg_u32 s98, 0
    s_cbranch_scc1 L_nof0
    s_mul_i32 s35, s15, 5
    s_cmp_eq_u32 s15, 3
    s_cselect_b32 s35, 14, s35
    s_mov_b32 s44, s28
    s_mov_b32 s45, s29
    s_mov_b32 s46, 5308416
    s_mov_b32 s47, 0x20000
    s_mov_b32 s48, s30
    s_mov_b32 s49, s31
    s_mov_b32 s50, 5308416
    s_mov_b32 s51, 0x20000
    s_mov_b32 s52, s32
    s_mov_b32 s53, s33
    s_mov_b32 s54, 5308416
    s_mov_b32 s55, 0x20000
    s_mov_b32 s56, s38
    s_mov_b32 s57, s39
    s_mov_b32 s58, 9216
    s_mov_b32 s59, 0x20000
    v_lshrrev_b32 v30, 2, v1
    v_mul_u32_u24 v30, 9216, v30
    v_and_b32 v5, 3, v1
    v_lshl_add_u32 v30, v5, 4, v30
    v_lshlrev_b32 v6, 4, v1
    v_mov_b32 v12, 133440
L_gpre:
    ds_read_b32 v13, v12 offset:24
    s_waitcnt lgkmcnt(0)
    v_readfirstlane_b32 s22, v13
    s_nop 0
    s_cmp_ge_u32 s22, 4
    s_cbranch_scc1 L_gpreok
    s_sleep 4
    s_sub_u32 s66, s66, 1
    s_cmp_lg_u32 s66, 0
    s_cbranch_scc1 L_gpre
    s_branch L_exit
L_gpreok:
    s_mul_i32 s64, s35, 294912
    s_lshl_b32 s65, s14, 6
    s_add_u32 s64, s64, s65
    s_add_u32 m0, s101, 0
    s_nop 0
    buffer_load_dwordx4 v30, s[44:47], s64 offen  lds
    s_add_u32 s64, s64, 147456
    s_add_u32 m0, s101, 1024
    s_nop 0
    buffer_load_dwordx4 v30, s[44:47], s64 offen  lds
    s_add_u32 s64, s64, 147456
    s_add_u32 m0, s101, 2048
    s_nop 0
    buffer_load_dwordx4 v30, s[44:47], s64 offen  lds
    s_add_u32 s64, s64, 147456
    s_add_u32 m0, s101, 3072
    s_nop 0
    buffer_load_dwordx4 v30, s[44:47], s64 offen  lds
    s_add_u32 s64, s64, 147456
    s_add_u32 m0, s101, 4096
    s_nop 0
    buffer_load_dwordx4 v30, s[44:47], s64 offen  lds
    s_add_u32 s64, s64, 147456
    s_waitcnt vmcnt(4)
    s_add_u32 m0, s101, 5120
    s_nop 0
    buffer_load_dwordx4 v30, s[44:47], s64 offen  lds
    s_add_u32 s64, s64, 147456
    s_waitcnt vmcnt(4)
    s_add_u32 m0, s101, 6144
    s_nop 0
    buffer_load_dwordx4 v30, s[44:47], s64 offen  lds
    s_add_u32 s64, s64, 147456
    s_waitcnt vmcnt(4)
    s_add_u32 m0, s101, 7168
    s_nop 0
    buffer_load_dwordx4 v30, s[44:47], s64 offen  lds
    s_add_u32 s64, s64, 147456
    s_cmp_ge_u32 s15, 2
    s_cbranch_scc1 L_sg_18
    s_waitcnt vmcnt(4)
    s_add_u32 m0, s101, 8192
    s_nop 0
    buffer_load_dwordx4 v30, s[44:47], s64 offen  lds
    s_add_u32 s64, s64, 147456
    s_waitcnt vmcnt(4)
    s_add_u32 m0, s101, 9216
    s_nop 0
    buffer_load_dwordx4 v30, s[44:47], s64 offen  lds
    s_add_u32 s64, s64, 147456
L_sg_18:
L_nof0:
    s_cmp_lg_u32 s15, 0
    s_cbranch_scc1 L_qdone
    s_lshl_b32 s62, s10, 13
    s_lshl_b32 s63, s11, 8
    s_add_u32 s62, s62, s63
    s_add_u32 s62, s62, 262144
    v_lshlrev_b32 v4, 11, v2
    v_lshl_add_u32 v4, v3, 4, v4
    v_lshlrev_b32 v5, 3, v1
    v_add_u32 v5, 132928, v5
    v_mov_b32 v12, 133440
    v_mov_b32 v13, 1
L_qpoll:
    buffer_load_dwordx4 v[24:27], v4, s[4:7], s62 offen offset:0 sc1
    s_waitcnt vmcnt(0)
    v_bitop3_b32 v10, v25, v27, s8 bitop3:0x7e
    v_cmp_ne_u32 vcc, 0, v10
    s_nop 0
    s_cbranch_vccz L_qpollok
    s_sleep 2
    s_sub_u32 s66, s66, 1
    s_cmp_lg_u32 s66, 0
    s_cbranch_scc1 L_qpoll
    s_branch L_exit
L_qpollok:
    ds_write2_b32 v5, v24, v26 offset0:0 offset1:1
    ds_write_b32 v12, v13 offset:4
L_qdone:
    s_cmp_eq_u32 s98, 1
    s_cbranch_scc1 L_wrole
    s_cmp_eq_u32 s98, 3
    s_cbranch_scc1 L_nrole
    s_mul_i32 s35, s15, 5
    s_cmp_eq_u32 s15, 3
    s_cselect_b32 s35, 14, s35
    s_mov_b32 s44, s28
    s_mov_b32 s45, s29
    s_mov_b32 s46, 5308416
    s_mov_b32 s47, 0x20000
    s_mov_b32 s48, s30
    s_mov_b32 s49, s31
    s_mov_b32 s50, 5308416
    s_mov_b32 s51, 0x20000
    s_mov_b32 s52, s32
    s_mov_b32 s53, s33
    s_mov_b32 s54, 5308416
    s_mov_b32 s55, 0x20000
    s_mov_b32 s56, s38
    s_mov_b32 s57, s39
    s_mov_b32 s58, 9216
    s_mov_b32 s59, 0x20000
    v_lshrrev_b32 v30, 2, v1
    v_mul_u32_u24 v30, 9216, v30
    v_and_b32 v5, 3, v1
    v_lshl_add_u32 v30, v5, 4, v30
    v_lshlrev_b32 v6, 4, v1
    v_and_b32 v8, 7, v3
    v_lshlrev_b32 v20, 4, v8
    v_lshl_add_u32 v20, s14, 7, v20
    v_mul_u32_u24 v21, 1152, v8
    v_lshl_add_u32 v21, s14, 3, v21
    v_mov_b32 v240, 0
    v_mov_b32 v241, 0
    v_mov_b32 v242, 0
    v_mov_b32 v243, 0
    v_mov_b32 v244, 0
    v_mov_b32 v245, 0
    v_mov_b32 v246, 0
    v_mov_b32 v247, 0
    v_mov_b32 v248, 0
    v_mov_b32 v249, 0
    v_mov_b32 v250, 0
    v_mov_b32 v251, 0
    v_mov_b32 v252, 0
    v_mov_b32 v253, 0
    v_mov_b32 v254, 0
    v_mov_b32 v255, 0
    v_mov_b32 v60, 0
    v_mov_b32 v61, 0
    v_mov_b32 v62, 0
    v_mov_b32 v63, 0
    v_mov_b32 v64, 0
    v_mov_b32 v65, 0
    v_mov_b32 v66, 0
    v_mov_b32 v67, 0
    v_and_b32 v8, 1, v3
    v_lshlrev_b32 v8, 4, v8
    v_mov_b32 v9, 0x3f80
    v_lshlrev_b32 v9, v8, v9
    v_and_b32 v8, 2, v3
    v_cmp_eq_u32 vcc, 0, v8
    s_nop 1
    v_cndmask_b32 v76, 0, v9, vcc
    v_sub_u32 v78, v9, v76
    v_mov_b32 v77, 0
    v_mov_b32 v79, 0
    v_mov_b32 v81, 0
    v_mov_b32 v83, 0
    s_cmp_lt_u32 s15, 2
    s_cselect_b32 s62, -1, 0
    v_and_b32 v80, s62, v76
    v_and_b32 v82, s62, v78
    s_mov_b32 s68, 0xff00ff
    s_mov_b32 s69, 0xff00ff
    v_lshrrev_b32 v8, 2, v3
    v_and_b32 v9, 3, v3
    v_lshlrev_b32 v16, 6, v8
    v_lshl_add_u32 v16, v9, 3, v16
    v_add_u32 v16, s101, v16
    v_lshl_add_u32 v16, v2, 9, v16
    v_mul_u32_u24 v31, 1152, v8
    v_lshl_add_u32 v31, v9, 3, v31
    v_mul_u32_u24 v10, 29696, v2
    s_mul_i32 s62, s15, 288
    s_add_u32 s62, s62, 20480
    v_add3_u32 v31, v31, v10, s62
    v_and_b32 v8, 7, v3
    v_lshrrev_b32 v9, 3, v3
    s_cmp_lt_u32 s15, 2
    s_cselect_b32 s62, -1, 0
    v_add_u32 v23, 4096, v6
    v_and_b32 v23, s62, v23
    v_add_u32 v17, 16384, v6
    v_and_b32 v17, s62, v17
    v_mul_u32_u24 v5, 18432, v2
    v_lshl_add_u32 v5, v8, 4, v5
    v_lshl_add_u32 v7, v9, 30, v5
    v_mul_u32_u24 v10, 73728, v9
    v_add_u32 v5, v5, v10
    v_mul_u32_u24 v14, 272, v8
    v_lshl_add_u32 v15, v2, 5, v14
    v_lshl_add_u32 v15, v9, 4, v15
    v_add_u32 v15, 118784, v15
    s_mul_i32 s62, s15, 2176
    s_add_u32 s62, s62, 118784
    v_lshl_add_u32 v14, v2, 4, v14
    v_add_u32 v14, s62, v14
    v_lshlrev_b32 v19, 4, v8
    v_add_u32 v19, 127744, v19
    s_lshl_b32 s62, s15, 7
    v_add_u32 v18, s62, v19
    s_waitcnt vmcnt(0)
    ds_read_b64_tr_b16 v[176:177], v16 offset:0
    ds_read_b64_tr_b16 v[178:179], v16 offset:256
    ds_read_b64_tr_b16 v[180:181], v16 offset:32
    ds_read_b64_tr_b16 v[182:183], v16 offset:288
    ds_read_b64_tr_b16 v[192:193], v16 offset:2048
    ds_read_b64_tr_b16 v[194:195], v16 offset:2304
    ds_read_b64_tr_b16 v[196:197], v16 offset:2080
    ds_read_b64_tr_b16 v[198:199], v16 offset:2336
    ds_read_b64_tr_b16 v[208:209], v16 offset:4096
    ds_read_b64_tr_b16 v[210:211], v16 offset:4352
    ds_read_b64_tr_b16 v[212:213], v16 offset:4128
    ds_read_b64_tr_b16 v[214:215], v16 offset:4384
    s_waitcnt lgkmcnt(4)
    ds_read_b64_tr_b16 v[224:225], v16 offset:6144
    ds_read_b64_tr_b16 v[226:227], v16 offset:6400
    ds_read_b64_tr_b16 v[228:229], v16 offset:6176
    ds_read_b64_tr_b16 v[230:231], v16 offset:6432
    s_cmp_ge_u32 s15, 2
    s_cbranch_scc1 L_cv_19
    ds_read_b64_tr_b16 v[240:241], v16 offset:8192
    ds_read_b64_tr_b16 v[242:243], v16 offset:8448
    ds_read_b64_tr_b16 v[244:245], v16 offset:8224
    ds_read_b64_tr_b16 v[246:247], v16 offset:8480
L_cv_19:
    s_waitcnt lgkmcnt(0)
    v_mov_b32 v12, 133440
L_gloc:
    ds_read_b32 v13, v12 offset:16
    s_waitcnt lgkmcnt(0)
    v_readfirstlane_b32 s22, v13
    s_nop 0
    s_cmp_ge_u32 s22, 30
    s_cbranch_scc1 L_glocok
    s_sleep 64
    s_sub_u32 s66, s66, 1
    s_cmp_lg_u32 s66, 0
    s_cbranch_scc1 L_gloc
    s_branch L_exit
L_glocok:
    v_and_b32 v58, 31, v1
    v_lshlrev_b32 v58, 3, v58
    s_lshl_b32 s22, s12, 8
    s_add_u32 s22, s22, 65536
    buffer_load_dwordx2 v[56:57], v58, s[4:7], s22 offen sc1
    s_waitcnt vmcnt(0)
    s_getreg_b32 s22, hwreg(HW_REG_XCC_ID)
    v_xor_b32 v56, s22, v56
    v_xor_b32 v57, s8, v57
    v_or_b32 v56, v56, v57
    v_cmp_ne_u32 vcc, 0, v56
    s_nop 0
    s_cmp_eq_u64 vcc, 0
    s_cselect_b32 s34, 1, 0
    v_mov_b32 v13, s34
    ds_write_b32 v12, v13 offset:28
    s_mov_b32 s62, 223232
L_gbp:
    buffer_load_dwordx4 v[24:27], v20, s[4:7], s62 offen offset:0 sc1
    s_waitcnt vmcnt(0)
    v_bitop3_b32 v28, v25, v27, s8 bitop3:0x7e
    v_cmp_ne_u32 vcc, 0, v28
    s_nop 0
    s_cbranch_vccz L_gbpok
    s_sleep 32
    s_sub_u32 s66, s66, 1
    s_cmp_lg_u32 s66, 0
    s_cbranch_scc1 L_gbp
    s_branch L_exit
L_gbpok:
    v_lshlrev_b32 v68, 16, v24
    v_and_b32 v69, s60, v24
    v_lshlrev_b32 v70, 16, v26
    v_and_b32 v71, s60, v26
    s_mul_i32 s63, s12, 18432
    s_lshl_b32 s62, s35, 10
    s_add_u32 s62, s62, s63
    s_add_u32 s62, s62, 1310720
    s_add_u32 s63, s63, 1900544
    s_mul_i32 s72, s15, 663552
    s_lshl_b32 s73, s14, 7
    s_add_u32 s72, s72, s73
    s_add_u32 s72, s72, 2097152
    s_cmp_lg_u32 s15, 1
    s_cbranch_scc1 L_gbd
    v_mov_b32 v12, 133440
L_gkd:
    ds_read_b32 v13, v12 offset:32
    s_waitcnt lgkmcnt(0)
    v_readfirstlane_b32 s22, v13
    s_nop 0
    s_cmp_ge_u32 s22, 4
    s_cbranch_scc1 L_gkdok
    s_sleep 32
    s_sub_u32 s66, s66, 1
    s_cmp_lg_u32 s66, 0
    s_cbranch_scc1 L_gkd
    s_branch L_exit
L_gkdok:
    v_and_b32 v33, 1, v1
    v_lshlrev_b32 v33, 4, v33
    v_add_u32 v32, 133504, v33
    ds_read_b128 v[36:39], v32
    v_lshlrev_b32 v32, 3, v1
    v_add_u32 v32, 133888, v32
    s_mov_b32 s18, 16
    s_waitcnt lgkmcnt(0)
    v_max3_f32 v34, v36, v37, v38
    v_max_f32 v34, v34, v39
    v_mul_f32 v34, s61, v34
    v_mov_b32 v36, 0
L_gbl:
    ds_read2st64_b64 v[56:59], v32 offset0:0 offset1:1
    v_add_u32 v32, 1024, v32
    s_waitcnt lgkmcnt(0)
    v_lshlrev_b32 v38, 16, v56
    v_and_b32 v39, s60, v56
    v_fma_f32 v38, v38, s61, -v34
    v_fma_f32 v39, v39, s61, -v34
    v_exp_f32 v38, v38
    v_exp_f32 v39, v39
    v_add_f32 v36, v36, v38
    v_add_f32 v36, v36, v39
    v_lshlrev_b32 v38, 16, v57
    v_and_b32 v39, s60, v57
    v_fma_f32 v38, v38, s61, -v34
    v_fma_f32 v39, v39, s61, -v34
    v_exp_f32 v38, v38
    v_exp_f32 v39, v39
    v_add_f32 v36, v36, v38
    v_add_f32 v36, v36, v39
    v_lshlrev_b32 v38, 16, v58
    v_and_b32 v39, s60, v58
    v_fma_f32 v38, v38, s61, -v34
    v_fma_f32 v39, v39, s61, -v34
    v_exp_f32 v38, v38
    v_exp_f32 v39, v39
    v_add_f32 v36, v36, v38
    v_add_f32 v36, v36, v39
    v_lshlrev_b32 v38, 16, v59
    v_and_b32 v39, s60, v59
    v_fma_f32 v38, v38, s61, -v34
    v_fma_f32 v39, v39, s61, -v34
    v_exp_f32 v38, v38
    v_exp_f32 v39, v39
    v_add_f32 v36, v36, v38
    v_add_f32 v36, v36, v39
    s_sub_u32 s18, s18, 1
    s_cmp_lg_u32 s18, 0
    s_cbranch_scc1 L_gbl
    v_add_f32_dpp v36, v36, v36 quad_perm:[2,3,0,1] row_mask:0xf bank_mask:0xf
    s_nop 1
    v_add_f32_dpp v36, v36, v36 row_ror:4 row_mask:0xf bank_mask:0xf
    s_nop 1
    v_add_f32_dpp v36, v36, v36 row_ror:8 row_mask:0xf bank_mask:0xf
    v_mov_b32 v38, v36
    s_nop 1
    v_permlane16_swap_b32 v36, v38
    v_add_f32 v36, v36, v38
    v_mov_b32 v38, v36
    s_nop 1
    v_permlane32_swap_b32 v36, v38
    v_add_f32 v36, v36, v38
    v_mov_b32 v35, s8
    v_mov_b32 v37, s8
    s_lshl_b32 s20, s2, 7
    s_add_u32 s20, s20, 851968
    s_xor_b32 s21, s20, 1024
    s_mov_b64 exec, 3
    s_cmp_eq_u32 s34, 1
    s_cbranch_scc1 L_st_20a
    buffer_store_dwordx4 v[34:37], v33, s[4:7], s20 offen sc1
    s_branch L_st_20b
L_st_20a:
    buffer_store_dwordx4 v[34:37], v33, s[4:7], s20 offen
L_st_20b:
    v_mov_b32 v12, 133440
L_gxp:
    ds_read_b32 v13, v12 offset:16
    s_waitcnt lgkmcnt(0)
    v_readfirstlane_b32 s22, v13
    s_nop 0
    s_cmp_ge_u32 s22, 154
    s_cbranch_scc1 L_gxpok
    s_sleep 32
    s_sub_u32 s66, s66, 1
    s_cmp_lg_u32 s66, 0
    s_cbranch_scc1 L_gxp
    s_branch L_exit
L_gxpok:
L_gbalp:
    buffer_load_dwordx4 v[56:59], v33, s[4:7], s21 offen offset:0 sc1
    s_waitcnt vmcnt(0)
    v_bitop3_b32 v38, v57, v59, s8 bitop3:0x7e
    v_cmp_ne_u32 vcc, 0, v38
    s_nop 0
    s_cbranch_vccz L_gbalpok
    s_sleep 16
    s_sub_u32 s66, s66, 1
    s_cmp_lg_u32 s66, 0
    s_cbranch_scc1 L_gbalp
    s_branch L_exit
L_gbalpok:
    v_max_f32 v38, v34, v56
    v_sub_f32 v34, v34, v38
    v_sub_f32 v56, v56, v38
    v_exp_f32 v34, v34
    v_exp_f32 v56, v56
    v_mul_f32 v36, v36, v34
    v_fmac_f32 v36, v58, v56
    v_rcp_f32 v36, v36
    v_mov_b32 v35, 1
    v_mul_f32 v34, v34, v36
    v_lshrrev_b32 v33, 1, v33
    v_add_u32 v33, 133488, v33
    ds_write_b64 v33, v[34:35]
    s_waitcnt lgkmcnt(0)
    s_mov_b64 exec, -1
L_gbd:
    s_cmp_lg_u32 s15, 2
    s_cbranch_scc1 L_gpd
    v_mov_b32 v32, 133440
    v_and_b32 v33, 7, v1
    v_mul_u32_u24 v33, 4352, v33
    v_mov_b32 v35, s8
    s_lshr_b32 s18, s2, 5
    s_mul_i32 s18, s18, 5
    s_add_u32 s18, s18, s2
    s_and_b32 s19, s18, 31
    s_lshr_b32 s18, s2, 5
    s_mul_i32 s18, s18, 4352
    s_cmp_eq_u32 s19, 0
    s_cselect_b32 s18, s18, 0x7ff00000
    v_mov_b32 v12, 133440
L_gc0u:
    ds_read_b32 v13, v12 offset:16
    s_waitcnt lgkmcnt(0)
    v_readfirstlane_b32 s22, v13
    s_nop 0
    s_cmp_ge_u32 s22, 46
    s_cbranch_scc1 L_gc0uok
    s_sleep 32
    s_sub_u32 s66, s66, 1
    s_cmp_lg_u32 s66, 0
    s_cbranch_scc1 L_gc0u
    s_branch L_exit
L_gc0uok:
    v_mov_b32 v12, 133440
L_gc0v:
    ds_read_b32 v13, v12 offset:16
    s_waitcnt lgkmcnt(0)
    v_readfirstlane_b32 s22, v13
    s_nop 0
    s_cmp_ge_u32 s22, 52
    s_cbranch_scc1 L_gc0vok
    s_sleep 2
    s_sub_u32 s66, s66, 1
    s_cmp_lg_u32 s66, 0
    s_cbranch_scc1 L_gc0v
    s_branch L_exit
L_gc0vok:
    s_memrealtime s[20:21]
    s_add_u32 s19, s18, 1572864
    s_waitcnt lgkmcnt(0)
    v_mov_b32 v34, s20
    s_mov_b64 exec, 1
    buffer_store_dwordx2 v[34:35], off, s[4:7], s19 sc1
    s_mov_b64 exec, -1
    v_mov_b32 v12, 133440
L_gc0w:
    ds_read_b32 v13, v12 offset:16
    s_waitcnt lgkmcnt(0)
    v_readfirstlane_b32 s22, v13
    s_nop 0
    s_cmp_ge_u32 s22, 64
    s_cbranch_scc1 L_gc0wok
    s_sleep 16
    s_sub_u32 s66, s66, 1
    s_cmp_lg_u32 s66, 0
    s_cbranch_scc1 L_gc0w
    s_branch L_exit
L_gc0wok:
    s_mov_b32 s19, 1572864
    buffer_load_dwordx2 v[36:37], v33, s[4:7], s19 offen sc1
    s_waitcnt vmcnt(0)
    ds_read_b32 v38, v32 offset:16
    v_sub_u32 v36, v34, v36
    v_mov_b32 v39, -336
    v_cmp_eq_u32 vcc, v35, v37
    s_nop 1
    v_cndmask_b32 v36, v39, v36, vcc
    v_cvt_f32_i32 v36, v36
    s_nop 1
    v_add_f32_dpp v36, v36, v36 quad_perm:[1,0,3,2] row_mask:0xf bank_mask:0xf
    s_nop 1
    v_add_f32_dpp v36, v36, v36 quad_perm:[2,3,0,1] row_mask:0xf bank_mask:0xf
    s_nop 1
    v_add_f32_dpp v36, v36, v36 row_half_mirror row_mask:0xf bank_mask:0xf
    s_nop 1
    v_add_f32_dpp v36, v36, v36 row_mirror row_mask:0xf bank_mask:0xf
    v_mov_b32 v39, v36
    s_nop 1
    v_permlane16_swap_b32 v36, v39
    v_add_f32 v36, v36, v39
    v_mov_b32 v39, v36
    s_nop 1
    v_permlane32_swap_b32 v36, v39
    v_add_f32 v36, v36, v39
    v_mov_b32 v39, 0x40800000
    v_fmac_f32 v39, 0x3b1467e2, v36
    v_max_f32 v39, 0, v39
    v_min_f32 v39, 0x42800000, v39
    v_cvt_u32_f32 v39, v39
    s_waitcnt lgkmcnt(0)
    v_add3_u32 v38, v38, v39, 40
    ds_write_b32 v32, v38 offset:12
    s_waitcnt lgkmcnt(0)
    v_mov_b32 v56, v34
    v_mov_b32 v57, v36
    v_mov_b32 v12, 133440
L_gc1u:
    ds_read_b32 v13, v12 offset:16
    s_waitcnt lgkmcnt(0)
    v_readfirstlane_b32 s22, v13
    s_nop 0
    s_cmp_ge_u32 s22, 106
    s_cbranch_scc1 L_gc1uok
    s_sleep 32
    s_sub_u32 s66, s66, 1
    s_cmp_lg_u32 s66, 0
    s_cbranch_scc1 L_gc1u
    s_branch L_exit
L_gc1uok:
    v_mov_b32 v12, 133440
L_gc1v:
    ds_read_b32 v13, v12 offset:16
    s_waitcnt lgkmcnt(0)
    v_readfirstlane_b32 s22, v13
    s_nop 0
    s_cmp_ge_u32 s22, 112
    s_cbranch_scc1 L_gc1vok
    s_sleep 2
    s_sub_u32 s66, s66, 1
    s_cmp_lg_u32 s66, 0
    s_cbranch_scc1 L_gc1v
    s_branch L_exit
L_gc1vok:
    s_memrealtime s[20:21]
    s_add_u32 s19, s18, 1572992
    s_waitcnt lgkmcnt(0)
    v_mov_b32 v34, s20
    s_mov_b64 exec, 1
    buffer_store_dwordx2 v[34:35], off, s[4:7], s19 sc1
    s_mov_b64 exec, -1
    v_mov_b32 v12, 133440
L_gc1w:
    ds_read_b32 v13, v12 offset:16
    s_waitcnt lgkmcnt(0)
    v_readfirstlane_b32 s22, v13
    s_nop 0
    s_cmp_ge_u32 s22, 124
    s_cbranch_scc1 L_gc1wok
    s_sleep 16
    s_sub_u32 s66, s66, 1
    s_cmp_lg_u32 s66, 0
    s_cbranch_scc1 L_gc1w
    s_branch L_exit
L_gc1wok:
    s_mov_b32 s19, 1572992
    buffer_load_dwordx2 v[36:37], v33, s[4:7], s19 offen sc1
    s_waitcnt vmcnt(0)
    ds_read_b32 v38, v32 offset:16
    v_sub_u32 v36, v34, v36
    v_mov_b32 v39, -336
    v_cmp_eq_u32 vcc, v35, v37
    s_nop 1
    v_cndmask_b32 v36, v39, v36, vcc
    v_cvt_f32_i32 v36, v36
    s_nop 1
    v_add_f32_dpp v36, v36, v36 quad_perm:[1,0,3,2] row_mask:0xf bank_mask:0xf
    s_nop 1
    v_add_f32_dpp v36, v36, v36 quad_perm:[2,3,0,1] row_mask:0xf bank_mask:0xf
    s_nop 1
    v_add_f32_dpp v36, v36, v36 row_half_mirror row_mask:0xf bank_mask:0xf
    s_nop 1
    v_add_f32_dpp v36, v36, v36 row_mirror row_mask:0xf bank_mask:0xf
    v_mov_b32 v39, v36
    s_nop 1
    v_permlane16_swap_b32 v36, v39
    v_add_f32 v36, v36, v39
    v_mov_b32 v39, v36
    s_nop 1
    v_permlane32_swap_b32 v36, v39
    v_add_f32 v36, v36, v39
    v_mov_b32 v39, 0x40800000
    v_fmac_f32 v39, 0x3b1467e2, v36
    v_max_f32 v39, 0, v39
    v_min_f32 v39, 0x42800000, v39
    v_cvt_u32_f32 v39, v39
    s_waitcnt lgkmcnt(0)
    v_add3_u32 v38, v38, v39, 40
    ds_write_b32 v32, v38 offset:12
    s_waitcnt lgkmcnt(0)
    v_mov_b32 v56, v34
    v_mov_b32 v57, v36
    v_mov_b32 v12, 133440
L_gc2u:
    ds_read_b32 v13, v12 offset:16
    s_waitcnt lgkmcnt(0)
    v_readfirstlane_b32 s22, v13
    s_nop 0
    s_cmp_ge_u32 s22, 151
    s_cbranch_scc1 L_gc2uok
    s_sleep 32
    s_sub_u32 s66, s66, 1
    s_cmp_lg_u32 s66, 0
    s_cbranch_scc1 L_gc2u
    s_branch L_exit
L_gc2uok:
    v_mov_b32 v12, 133440
L_gc2v:
    ds_read_b32 v13, v12 offset:16
    s_waitcnt lgkmcnt(0)
    v_readfirstlane_b32 s22, v13
    s_nop 0
    s_cmp_ge_u32 s22, 157
    s_cbranch_scc1 L_gc2vok
    s_sleep 2
    s_sub_u32 s66, s66, 1
    s_cmp_lg_u32 s66, 0
    s_cbranch_scc1 L_gc2v
    s_branch L_exit
L_gc2vok:
    s_memrealtime s[20:21]
    s_add_u32 s19, s18, 1573120
    s_waitcnt lgkmcnt(0)
    v_mov_b32 v34, s20
    s_mov_b64 exec, 1
    buffer_store_dwordx2 v[34:35], off, s[4:7], s19 sc1
    s_mov_b64 exec, -1
    v_mov_b32 v12, 133440
L_gc2w:
    ds_read_b32 v13, v12 offset:16
    s_waitcnt lgkmcnt(0)
    v_readfirstlane_b32 s22, v13
    s_nop 0
    s_cmp_ge_u32 s22, 169
    s_cbranch_scc1 L_gc2wok
    s_sleep 16
    s_sub_u32 s66, s66, 1
    s_cmp_lg_u32 s66, 0
    s_cbranch_scc1 L_gc2w
    s_branch L_exit
L_gc2wok:
    s_mov_b32 s19, 1573120
    buffer_load_dwordx2 v[36:37], v33, s[4:7], s19 offen sc1
    s_waitcnt vmcnt(0)
    ds_read_b32 v38, v32 offset:16
    v_sub_u32 v36, v34, v36
    v_mov_b32 v39, -336
    v_cmp_eq_u32 vcc, v35, v37
    s_nop 1
    v_cndmask_b32 v36, v39, v36, vcc
    v_cvt_f32_i32 v36, v36
    s_nop 1
    v_add_f32_dpp v36, v36, v36 quad_perm:[1,0,3,2] row_mask:0xf bank_mask:0xf
    s_nop 1
    v_add_f32_dpp v36, v36, v36 quad_perm:[2,3,0,1] row_mask:0xf bank_mask:0xf
    s_nop 1
    v_add_f32_dpp v36, v36, v36 row_half_mirror row_mask:0xf bank_mask:0xf
    s_nop 1
    v_add_f32_dpp v36, v36, v36 row_mirror row_mask:0xf bank_mask:0xf
    v_mov_b32 v39, v36
    s_nop 1
    v_permlane16_swap_b32 v36, v39
    v_add_f32 v36, v36, v39
    v_mov_b32 v39, v36
    s_nop 1
    v_permlane32_swap_b32 v36, v39
    v_add_f32 v36, v36, v39
    v_mov_b32 v39, 0x40800000
    v_fmac_f32 v39, 0x3b1467e2, v36
    v_max_f32 v39, 0, v39
    v_min_f32 v39, 0x42800000, v39
    v_cvt_u32_f32 v39, v39
    s_waitcnt lgkmcnt(0)
    v_add3_u32 v38, v38, v39, 40
    ds_write_b32 v32, v38 offset:12
    s_waitcnt lgkmcnt(0)
    v_mov_b32 v56, v34
    v_mov_b32 v57, v36
    v_mov_b32 v12, 133440
L_gc3u:
    ds_read_b32 v13, v12 offset:16
    s_waitcnt lgkmcnt(0)
    v_readfirstlane_b32 s22, v13
    s_nop 0
    s_cmp_ge_u32 s22, 178
    s_cbranch_scc1 L_gc3uok
    s_sleep 32
    s_sub_u32 s66, s66, 1
    s_cmp_lg_u32 s66, 0
    s_cbranch_scc1 L_gc3u
    s_branch L_exit
L_gc3uok:
    v_mov_b32 v12, 133440
L_gc3v:
    ds_read_b32 v13, v12 offset:16
    s_waitcnt lgkmcnt(0)
    v_readfirstlane_b32 s22, v13
    s_nop 0
    s_cmp_ge_u32 s22, 184
    s_cbranch_scc1 L_gc3vok
    s_sleep 2
    s_sub_u32 s66, s66, 1
    s_cmp_lg_u32 s66, 0
    s_cbranch_scc1 L_gc3v
    s_branch L_exit
L_gc3vok:
    s_memrealtime s[20:21]
    s_add_u32 s19, s18, 1573248
    s_waitcnt lgkmcnt(0)
    v_mov_b32 v34, s20
    s_mov_b64 exec, 1
    buffer_store_dwordx2 v[34:35], off, s[4:7], s19 sc1
    s_mov_b64 exec, -1
    v_mov_b32 v12, 133440
L_gc3w:
    ds_read_b32 v13, v12 offset:16
    s_waitcnt lgkmcnt(0)
    v_readfirstlane_b32 s22, v13
    s_nop 0
    s_cmp_ge_u32 s22, 196
    s_cbranch_scc1 L_gc3wok
    s_sleep 16
    s_sub_u32 s66, s66, 1
    s_cmp_lg_u32 s66, 0
    s_cbranch_scc1 L_gc3w
    s_branch L_exit
L_gc3wok:
    s_mov_b32 s19, 1573248
    buffer_load_dwordx2 v[36:37], v33, s[4:7], s19 offen sc1
    s_waitcnt vmcnt(0)
    ds_read_b32 v38, v32 offset:16
    v_sub_u32 v36, v34, v36
    v_mov_b32 v39, -336
    v_cmp_eq_u32 vcc, v35, v37
    s_nop 1
    v_cndmask_b32 v36, v39, v36, vcc
    v_cvt_f32_i32 v36, v36
    s_nop 1
    v_add_f32_dpp v36, v36, v36 quad_perm:[1,0,3,2] row_mask:0xf bank_mask:0xf
    s_nop 1
    v_add_f32_dpp v36, v36, v36 quad_perm:[2,3,0,1] row_mask:0xf bank_mask:0xf
    s_nop 1
    v_add_f32_dpp v36, v36, v36 row_half_mirror row_mask:0xf bank_mask:0xf
    s_nop 1
    v_add_f32_dpp v36, v36, v36 row_mirror row_mask:0xf bank_mask:0xf
    v_mov_b32 v39, v36
    s_nop 1
    v_permlane16_swap_b32 v36, v39
    v_add_f32 v36, v36, v39
    v_mov_b32 v39, v36
    s_nop 1
    v_permlane32_swap_b32 v36, v39
    v_add_f32 v36, v36, v39
    v_sub_u32 v56, v34, v56
    v_cvt_f32_i32 v56, v56
    v_sub_f32 v57, v57, v36
    v_fmac_f32 v56, 0x3c800000, v57
    v_rcp_f32 v56, v56
    v_mul_f32 v36, 0x3c800000, v36
    v_mul_f32 v56, 0x41d80000, v56
    s_memrealtime s[20:21]
    ds_read_b32 v38, v32 offset:16
    s_waitcnt lgkmcnt(0)
    v_sub_u32 v39, s20, v34
    v_cvt_f32_i32 v39, v39
    v_add_f32 v39, v39, v36
    v_cvt_f32_u32 v58, v38
    v_subrev_f32 v58, 0x43390000, v58
    v_fma_f32 v39, v39, v56, -v58
    v_mul_f32 v39, 0x40800000, v39
    v_max_f32 v39, 0, v39
    v_min_f32 v39, 0x42800000, v39
    v_cvt_u32_f32 v39, v39
    v_add3_u32 v38, v38, v39, 40
    ds_write_b32 v32, v38 offset:12
    s_waitcnt lgkmcnt(0)
L_gpd:
    v_mov_b32 v40, 0
    v_mov_b32 v41, 0
    v_mov_b32 v42, 0
    v_mov_b32 v43, 0
    v_mov_b32 v44, 0
    v_mov_b32 v45, 0
    v_mov_b32 v46, 0
    v_mov_b32 v47, 0
    v_mov_b32 v48, 0
    v_mov_b32 v49, 0
    v_mov_b32 v50, 0
    v_mov_b32 v51, 0
    v_mov_b32 v52, 0
    v_mov_b32 v53, 0
    v_mov_b32 v54, 0
    v_mov_b32 v55, 0
    v_mov_b32 v12, 133440
L_gpub:
    ds_read_b32 v13, v12 offset:20
    s_waitcnt lgkmcnt(0)
    v_readfirstlane_b32 s22, v13
    s_nop 0
    s_cmp_ge_u32 s22, 1
    s_cbranch_scc1 L_gpubok
    s_sleep 1
    s_sub_u32 s66, s66, 1
    s_cmp_lg_u32 s66, 0
    s_cbranch_scc1 L_gpub
    s_branch L_exit
L_gpubok:
    s_mul_i32 s64, s35, 294912
    s_lshl_b32 s65, s14, 6
    s_add_u32 s64, s64, s65
    s_add_u32 m0, s101, 10240
    s_nop 0
    buffer_load_dwordx4 v30, s[48:51], s64 offen  lds
    s_add_u32 s64, s64, 147456
    s_add_u32 m0, s101, 11264
    s_nop 0
    buffer_load_dwordx4 v30, s[48:51], s64 offen  lds
    s_add_u32 s64, s64, 147456
    s_add_u32 m0, s101, 12288
    s_nop 0
    buffer_load_dwordx4 v30, s[48:51], s64 offen  lds
    s_add_u32 s64, s64, 147456
    s_add_u32 m0, s101, 13312
    s_nop 0
    buffer_load_dwordx4 v30, s[48:51], s64 offen  lds
    s_add_u32 s64, s64, 147456
    s_add_u32 m0, s101, 14336
    s_nop 0
    buffer_load_dwordx4 v30, s[48:51], s64 offen  lds
    s_add_u32 s64, s64, 147456
    s_add_u32 m0, s101, 15360
    s_nop 0
    buffer_load_dwordx4 v30, s[48:51], s64 offen  lds
    s_add_u32 s64, s64, 147456
    s_add_u32 m0, s101, 16384
    s_nop 0
    buffer_load_dwordx4 v30, s[48:51], s64 offen  lds
    s_add_u32 s64, s64, 147456
    s_add_u32 m0, s101, 17408
    s_nop 0
    buffer_load_dwordx4 v30, s[48:51], s64 offen  lds
    s_add_u32 s64, s64, 147456
    s_cmp_ge_u32 s15, 2
    s_cbranch_scc1 L_sg_21
    s_add_u32 m0, s101, 18432
    s_nop 0
    buffer_load_dwordx4 v30, s[48:51], s64 offen  lds
    s_add_u32 s64, s64, 147456
    s_add_u32 m0, s101, 19456
    s_nop 0
    buffer_load_dwordx4 v30, s[48:51], s64 offen  lds
    s_add_u32 s64, s64, 147456
L_sg_21:
    s_mul_i32 s64, s14, 36864
    s_mul_i32 s65, s15, 9216
    s_add_u32 s64, s64, s65
    s_add_u32 m0, s101, 20480
    s_nop 0
    buffer_load_dwordx4 v6, s[52:55], s64 offen nt lds
    s_add_u32 s64, s64, 1024
    s_add_u32 m0, s101, 21504
    s_nop 0
    buffer_load_dwordx4 v6, s[52:55], s64 offen nt lds
    s_add_u32 s64, s64, 1024
    s_add_u32 m0, s101, 22528
    s_nop 0
    buffer_load_dwordx4 v6, s[52:55], s64 offen nt lds
    s_add_u32 s64, s64, 1024
    s_add_u32 m0, s101, 23552
    s_nop 0
    buffer_load_dwordx4 v6, s[52:55], s64 offen nt lds
    s_add_u32 s64, s64, 1024
    s_add_u32 m0, s101, 24576
    s_nop 0
    buffer_load_dwordx4 v6, s[52:55], s64 offen nt lds
    s_add_u32 s64, s64, 1024
    s_add_u32 m0, s101, 25600
    s_nop 0
    buffer_load_dwordx4 v6, s[52:55], s64 offen nt lds
    s_add_u32 s64, s64, 1024
    s_add_u32 m0, s101, 26624
    s_nop 0
    buffer_load_dwordx4 v6, s[52:55], s64 offen nt lds
    s_add_u32 s64, s64, 1024
    s_add_u32 m0, s101, 27648
    s_nop 0
    buffer_load_dwordx4 v6, s[52:55], s64 offen nt lds
    s_add_u32 s64, s64, 1024
    s_add_u32 m0, s101, 28672
    s_nop 0
    buffer_load_dwordx4 v6, s[52:55], s64 offen nt lds
    s_add_u32 s64, s64, 1024
L_sg_22:
    s_waitcnt vmcnt(9)
    ds_read_b64_tr_b16 v[184:185], v16 offset:10240
    ds_read_b64_tr_b16 v[186:187], v16 offset:10496
    ds_read_b64_tr_b16 v[188:189], v16 offset:10272
    ds_read_b64_tr_b16 v[190:191], v16 offset:10528
    ds_read_b64_tr_b16 v[200:201], v16 offset:12288
    ds_read_b64_tr_b16 v[202:203], v16 offset:12544
    ds_read_b64_tr_b16 v[204:205], v16 offset:12320
    ds_read_b64_tr_b16 v[206:207], v16 offset:12576
    ds_read_b64_tr_b16 v[216:217], v16 offset:14336
    ds_read_b64_tr_b16 v[218:219], v16 offset:14592
    ds_read_b64_tr_b16 v[220:221], v16 offset:14368
    ds_read_b64_tr_b16 v[222:223], v16 offset:14624
    s_waitcnt lgkmcnt(4)
    ds_read_b64_tr_b16 v[232:233], v16 offset:16384
    ds_read_b64_tr_b16 v[234:235], v16 offset:16640
    ds_read_b64_tr_b16 v[236:237], v16 offset:16416
    ds_read_b64_tr_b16 v[238:239], v16 offset:16672
    s_cmp_ge_u32 s15, 2
    s_cbranch_scc1 L_cv_23
    ds_read_b64_tr_b16 v[248:249], v16 offset:18432
    ds_read_b64_tr_b16 v[250:251], v16 offset:18688
    ds_read_b64_tr_b16 v[252:253], v16 offset:18464
    ds_read_b64_tr_b16 v[254:255], v16 offset:18720
L_cv_23:
    s_waitcnt lgkmcnt(0)
    s_waitcnt vmcnt(0)
    s_barrier
    buffer_load_dwordx4 v[100:103], v23, s[4:7], s62 offen offset:0 sc1
    buffer_load_dwordx4 v[84:87], v6, s[4:7], s62 offen offset:0 sc1
    buffer_load_dwordx4 v[88:91], v6, s[4:7], s62 offen offset:1024 sc1
    buffer_load_dwordx4 v[92:95], v6, s[4:7], s62 offen offset:2048 sc1
    buffer_load_dwordx4 v[96:99], v6, s[4:7], s62 offen offset:3072 sc1
    ds_read_b64_tr_b16 v[140:141], v31 offset:0
    ds_read_b64_tr_b16 v[142:143], v31 offset:4608
    ds_read_b64_tr_b16 v[144:145], v31 offset:32
    ds_read_b64_tr_b16 v[146:147], v31 offset:4640
    ds_read_b64_tr_b16 v[148:149], v31 offset:64
    ds_read_b64_tr_b16 v[150:151], v31 offset:4672
    ds_read_b64_tr_b16 v[152:153], v31 offset:96
    ds_read_b64_tr_b16 v[154:155], v31 offset:4704
    ds_read_b64_tr_b16 v[156:157], v31 offset:128
    ds_read_b64_tr_b16 v[158:159], v31 offset:4736
    ds_read_b64_tr_b16 v[160:161], v31 offset:160
    ds_read_b64_tr_b16 v[162:163], v31 offset:4768
    s_waitcnt lgkmcnt(6)
    ds_read_b64_tr_b16 v[164:165], v31 offset:192
    ds_read_b64_tr_b16 v[166:167], v31 offset:4800
    ds_read_b64_tr_b16 v[168:169], v31 offset:224
    ds_read_b64_tr_b16 v[170:171], v31 offset:4832
    ds_read_b64_tr_b16 v[172:173], v31 offset:256
    ds_read_b64_tr_b16 v[174:175], v31 offset:4864
    s_waitcnt lgkmcnt(0)
L_h2p:
    s_waitcnt vmcnt(0)
    v_bitop3_b32 v12, v101, v103, s8 bitop3:0x7e
    v_bitop3_b32 v10, v85, v87, s8 bitop3:0x7e
    v_bitop3_b32 v11, v89, v91, s8 bitop3:0x7e
    v_or3_b32 v12, v12, v10, v11
    v_bitop3_b32 v10, v93, v95, s8 bitop3:0x7e
    v_bitop3_b32 v11, v97, v99, s8 bitop3:0x7e
    v_or3_b32 v12, v12, v10, v11
    v_cmp_ne_u32 vcc, 0, v12
    s_nop 0
    s_cbranch_vccz L_h2pok
    s_mov_b64 exec, vcc
    buffer_load_dwordx4 v[100:103], v23, s[4:7], s62 offen offset:0 sc1
    buffer_load_dwordx4 v[84:87], v6, s[4:7], s62 offen offset:0 sc1
    buffer_load_dwordx4 v[88:91], v6, s[4:7], s62 offen offset:1024 sc1
    buffer_load_dwordx4 v[92:95], v6, s[4:7], s62 offen offset:2048 sc1
    buffer_load_dwordx4 v[96:99], v6, s[4:7], s62 offen offset:3072 sc1
    s_sub_u32 s66, s66, 1
    s_cmp_lg_u32 s66, 0
    s_cbranch_scc1 L_h2p
    s_branch L_exit
L_h2pok:
    s_mov_b64 exec, -1
    v_mov_b32_dpp v87, v86 row_ror:8 row_mask:0xf bank_mask:0xf
    v_mov_b32 v85, v86
    v_mov_b32_dpp v86, v84 row_ror:8 row_mask:0xf bank_mask:0xf
    s_nop 1
    v_mfma_f32_16x16x32_bf16 v[40:43], v[176:179], v[84:87], 0
    v_mov_b32_dpp v91, v90 row_ror:8 row_mask:0xf bank_mask:0xf
    v_mov_b32 v89, v90
    v_mov_b32_dpp v90, v88 row_ror:8 row_mask:0xf bank_mask:0xf
    v_mfma_f32_16x16x32_bf16 v[44:47], v[180:183], v[84:87], 0
    v_mfma_f32_16x16x32_bf16 v[48:51], v[184:187], v[84:87], 0
    v_mfma_f32_16x16x32_bf16 v[52:55], v[188:191], v[84:87], 0
    v_mfma_f32_16x16x32_bf16 v[40:43], v[192:195], v[88:91], v[40:43]
    v_mov_b32_dpp v95, v94 row_ror:8 row_mask:0xf bank_mask:0xf
    v_mov_b32 v93, v94
    v_mov_b32_dpp v94, v92 row_ror:8 row_mask:0xf bank_mask:0xf
    v_mfma_f32_16x16x32_bf16 v[44:47], v[196:199], v[88:91], v[44:47]
    v_mfma_f32_16x16x32_bf16 v[48:51], v[200:203], v[88:91], v[48:51]
    v_mfma_f32_16x16x32_bf16 v[52:55], v[204:207], v[88:91], v[52:55]
    v_mfma_f32_16x16x32_bf16 v[40:43], v[208:211], v[92:95], v[40:43]
    v_mov_b32_dpp v99, v98 row_ror:8 row_mask:0xf bank_mask:0xf
    v_mov_b32 v97, v98
    v_mov_b32_dpp v98, v96 row_ror:8 row_mask:0xf bank_mask:0xf
    v_mfma_f32_16x16x32_bf16 v[44:47], v[212:215], v[92:95], v[44:47]
    v_mfma_f32_16x16x32_bf16 v[48:51], v[216:219], v[92:95], v[48:51]
    v_mfma_f32_16x16x32_bf16 v[52:55], v[220:223], v[92:95], v[52:55]
    v_mfma_f32_16x16x32_bf16 v[40:43], v[224:227], v[96:99], v[40:43]
    v_mov_b32_dpp v103, v102 row_ror:8 row_mask:0xf bank_mask:0xf
    v_mov_b32 v101, v102
    v_mov_b32_dpp v102, v100 row_ror:8 row_mask:0xf bank_mask:0xf
    v_mfma_f32_16x16x32_bf16 v[44:47], v[228:231], v[96:99], v[44:47]
    v_mfma_f32_16x16x32_bf16 v[48:51], v[232:235], v[96:99], v[48:51]
    v_mfma_f32_16x16x32_bf16 v[52:55], v[236:239], v[96:99], v[52:55]
    v_mfma_f32_16x16x32_bf16 v[40:43], v[240:243], v[100:103], v[40:43]
    v_mfma_f32_16x16x32_bf16 v[44:47], v[244:247], v[100:103], v[44:47]
    v_mfma_f32_16x16x32_bf16 v[48:51], v[248:251], v[100:103], v[48:51]
    v_mfma_f32_16x16x32_bf16 v[52:55], v[252:255], v[100:103], v[52:55]
    s_mov_b64 exec, s[68:69]
    s_nop 3
    ds_write_b128 v14, v[40:43] offset:0
    ds_write_b128 v14, v[44:47] offset:64
    ds_write_b128 v14, v[48:51] offset:128
    ds_write_b128 v14, v[52:55] offset:192
    s_mov_b64 exec, -1
    v_mov_b32 v177, s8
    v_mov_b32 v179, s8
    v_mov_b32 v181, s8
    v_mov_b32 v183, s8
    v_mov_b32 v185, s8
    v_mov_b32 v187, s8
    v_mov_b32 v189, s8
    v_mov_b32 v191, s8
    v_mov_b32 v193, s8
    v_mov_b32 v195, s8
    s_mov_b32 s64, 0xbdd2d3e8
    v_mov_b32 v13, 0xc0135761
    s_waitcnt lgkmcnt(0)
    s_barrier
    ds_read_b128 v[104:107], v15 offset:0
    ds_read_b128 v[108:111], v15 offset:2176
    ds_read_b128 v[112:115], v15 offset:4352
    ds_read_b128 v[116:119], v15 offset:6528
    ds_read_b128 v[120:123], v15 offset:128
    ds_read_b128 v[124:127], v15 offset:2304
    ds_read_b128 v[128:131], v15 offset:4480
    ds_read_b128 v[132:135], v15 offset:6656
    v_mov_b32 v40, 0
    v_mov_b32 v41, 0
    v_mov_b32 v42, 0
    v_mov_b32 v43, 0
    s_mul_i32 s73, s14, 18432
    s_lshl_b32 s74, s15, 10
    s_add_u32 s73, s73, s74
    s_add_u32 s73, s73, 2097152
    s_add_u32 s74, s73, 4096
    s_add_u32 s75, s73, 8192
    s_add_u32 s76, s73, 12288
    s_waitcnt lgkmcnt(4)
    v_add_f32 v104, v104, v108
    v_add_f32 v112, v112, v116
    v_add_f32 v105, v105, v109
    v_add_f32 v113, v113, v117
    v_add_f32 v106, v106, v110
    v_add_f32 v114, v114, v118
    v_add_f32 v107, v107, v111
    v_add_f32 v115, v115, v119
    v_add_f32 v104, v104, v112
    v_add_f32 v105, v105, v113
    v_add_f32 v106, v106, v114
    v_add_f32 v107, v107, v115
    v_mul_f32 v108, v104, v104
    v_mul_f32 v109, v105, v105
    v_mul_f32 v110, v106, v106
    v_mul_f32 v111, v107, v107
    v_fma_f32 v108, v108, s64, v13
    v_fma_f32 v109, v109, s64, v13
    v_fma_f32 v110, v110, s64, v13
    v_fma_f32 v111, v111, s64, v13
    v_mul_f32 v108, v108, v104
    v_mul_f32 v109, v109, v105
    v_mul_f32 v110, v110, v106
    v_mul_f32 v111, v111, v107
    v_exp_f32 v108, v108
    v_exp_f32 v109, v109
    v_exp_f32 v110, v110
    v_exp_f32 v111, v111
    s_waitcnt lgkmcnt(0)
    v_add_f32 v120, v120, v124
    v_add_f32 v128, v128, v132
    v_add_f32 v121, v121, v125
    v_add_f32 v129, v129, v133
    v_add_f32 v122, v122, v126
    v_add_f32 v130, v130, v134
    v_add_f32 v123, v123, v127
    v_add_f32 v131, v131, v135
    v_add_f32 v120, v120, v128
    v_add_f32 v121, v121, v129
    v_add_f32 v122, v122, v130
    v_add_f32 v123, v123, v131
    v_add_f32 v108, 1.0, v108
    v_add_f32 v109, 1.0, v109
    v_add_f32 v110, 1.0, v110
    v_add_f32 v111, 1.0, v111
    v_rcp_f32 v108, v108
    v_rcp_f32 v109, v109
    v_rcp_f32 v110, v110
    v_rcp_f32 v111, v111
    v_mul_f32 v104, v104, v108
    v_mul_f32 v105, v105, v109
    v_mul_f32 v106, v106, v110
    v_mul_f32 v107, v107, v111
    v_mul_f32 v104, v104, v120
    v_mul_f32 v105, v105, v121
    v_mul_f32 v106, v106, v122
    v_mul_f32 v107, v107, v123
    v_cvt_pk_bf16_f32 v8, v104, v105
    v_cvt_pk_bf16_f32 v9, v106, v107
    s_nop 0
    v_mov_b32_dpp v60, v8 quad_perm:[0,1,2,3] row_mask:0xf bank_mask:0x3
    v_mov_b32_dpp v61, v9 quad_perm:[0,1,2,3] row_mask:0xf bank_mask:0x3
    v_mov_b32_dpp v62, v8 row_ror:8 row_mask:0xf bank_mask:0x3
    v_mov_b32_dpp v63, v9 row_ror:8 row_mask:0xf bank_mask:0x3
    v_mov_b32_dpp v64, v8 row_ror:8 row_mask:0xf bank_mask:0xc
    v_mov_b32_dpp v65, v9 row_ror:8 row_mask:0xf bank_mask:0xc
    v_mov_b32_dpp v66, v8 quad_perm:[0,1,2,3] row_mask:0xf bank_mask:0xc
    v_mov_b32_dpp v67, v9 quad_perm:[0,1,2,3] row_mask:0xf bank_mask:0xc
    v_mfma_f32_16x16x32_bf16 v[104:107], v[140:143], v[60:63], 0
    s_nop 0
    v_mfma_f32_16x16x32_bf16 v[104:107], v[144:147], v[64:67], v[104:107]
    v_mfma_f32_16x16x32_bf16 v[108:111], v[148:151], v[60:63], 0
    v_mfma_f32_16x16x32_bf16 v[108:111], v[152:155], v[64:67], v[108:111]
    v_mfma_f32_16x16x32_bf16 v[112:115], v[156:159], v[60:63], 0
    v_mfma_f32_16x16x32_bf16 v[112:115], v[160:163], v[64:67], v[112:115]
    s_nop 3
    v_cvt_pk_bf16_f32 v176, v104, v105
    v_cvt_pk_bf16_f32 v178, v106, v107
    buffer_store_dwordx4 v[176:179], v5, s[4:7], s72 offen sc1
    s_add_u32 s72, s72, 147456
    v_mfma_f32_16x16x32_bf16 v[116:119], v[164:167], v[60:63], 0
    v_mfma_f32_16x16x32_bf16 v[116:119], v[168:171], v[64:67], v[116:119]
    v_cvt_pk_bf16_f32 v180, v108, v109
    v_cvt_pk_bf16_f32 v182, v110, v111
    buffer_store_dwordx4 v[180:183], v5, s[4:7], s72 offen sc1
    s_add_u32 s72, s72, 147456
    v_mfma_f32_16x16x32_bf16 v[120:123], v[172:175], v[60:63], 0
    v_cvt_pk_bf16_f32 v184, v112, v113
    v_cvt_pk_bf16_f32 v186, v114, v115
    buffer_store_dwordx4 v[184:187], v5, s[4:7], s72 offen sc1
    s_add_u32 s72, s72, 147456
    v_cvt_pk_bf16_f32 v188, v116, v117
    v_cvt_pk_bf16_f32 v190, v118, v119
    buffer_store_dwordx4 v[188:191], v5, s[4:7], s72 offen sc1
    s_add_u32 s72, s72, 147456
    v_cvt_pk_bf16_f32 v192, v120, v121
    v_cvt_pk_bf16_f32 v194, v122, v123
    buffer_store_dwordx4 v[192:195], v7, s[4:7], s72 offen sc1
    s_waitcnt vmcnt(0)
    buffer_load_dwordx4 v[84:87], v6, s[4:7], s73 offen offset:0 sc1
    buffer_load_dwordx4 v[88:91], v6, s[4:7], s74 offen offset:0 sc1
    buffer_load_dwordx4 v[92:95], v6, s[4:7], s75 offen offset:0 sc1
    buffer_load_dwordx4 v[96:99], v6, s[4:7], s76 offen offset:0 sc1
    buffer_load_dwordx4 v[100:103], v17, s[4:7], s73 offen offset:0 sc1
    buffer_load_dwordx4 v[72:75], v20, s[4:7], s63 offen offset:0 sc1
L_yp:
    s_waitcnt vmcnt(0)
    v_bitop3_b32 v12, v85, v87, s8 bitop3:0x7e
    v_bitop3_b32 v10, v89, v91, s8 bitop3:0x7e
    v_bitop3_b32 v11, v93, v95, s8 bitop3:0x7e
    v_or3_b32 v12, v12, v10, v11
    v_bitop3_b32 v10, v97, v99, s8 bitop3:0x7e
    v_bitop3_b32 v11, v101, v103, s8 bitop3:0x7e
    v_or3_b32 v12, v12, v10, v11
    v_bitop3_b32 v10, v73, v75, s8 bitop3:0x7e
    v_or_b32 v12, v12, v10
    v_cmp_ne_u32 vcc, 0, v12
    s_nop 0
    s_cbranch_vccz L_ypok
    s_mov_b64 exec, vcc
    buffer_load_dwordx4 v[84:87], v6, s[4:7], s73 offen offset:0 sc1
    buffer_load_dwordx4 v[88:91], v6, s[4:7], s74 offen offset:0 sc1
    buffer_load_dwordx4 v[92:95], v6, s[4:7], s75 offen offset:0 sc1
    buffer_load_dwordx4 v[96:99], v6, s[4:7], s76 offen offset:0 sc1
    buffer_load_dwordx4 v[100:103], v17, s[4:7], s73 offen offset:0 sc1
    buffer_load_dwordx4 v[72:75], v20, s[4:7], s63 offen offset:0 sc1
    s_sub_u32 s66, s66, 1
    s_cmp_lg_u32 s66, 0
    s_cbranch_scc1 L_yp
    s_branch L_exit
L_ypok:
    s_mov_b64 exec, -1
    v_mfma_f32_16x16x32_bf16 v[40:43], v[76:79], v[84:87], v[40:43]
    v_mfma_f32_16x16x32_bf16 v[40:43], v[76:79], v[88:91], v[40:43]
    v_mfma_f32_16x16x32_bf16 v[40:43], v[76:79], v[92:95], v[40:43]
    v_mfma_f32_16x16x32_bf16 v[40:43], v[76:79], v[96:99], v[40:43]
    v_mfma_f32_16x16x32_bf16 v[40:43], v[80:83], v[100:103], v[40:43]
    v_lshlrev_b32 v24, 16, v72
    v_and_b32 v25, s60, v72
    v_lshlrev_b32 v26, 16, v74
    v_and_b32 v27, s60, v74
    s_nop 3
    v_add_f32_dpp v40, v40, v40 row_ror:8 row_mask:0xf bank_mask:0xf
    v_add_f32_dpp v41, v41, v41 row_ror:8 row_mask:0xf bank_mask:0xf
    v_add_f32_dpp v42, v42, v42 row_ror:8 row_mask:0xf bank_mask:0xf
    v_add_f32_dpp v43, v43, v43 row_ror:8 row_mask:0xf bank_mask:0xf
    s_mov_b64 exec, 0xff
    ds_write_b128 v18, v[40:43]
    s_waitcnt lgkmcnt(0)
    s_barrier
    s_cmp_lg_u32 s15, 0
    s_cbranch_scc1 L_exit
    ds_read_b128 v[104:107], v19 offset:0
    ds_read_b128 v[108:111], v19 offset:128
    ds_read_b128 v[112:115], v19 offset:256
    ds_read_b128 v[116:119], v19 offset:384
    s_waitcnt lgkmcnt(0)
    v_add_f32 v104, v104, v108
    v_add_f32 v112, v112, v116
    v_add_f32 v105, v105, v109
    v_add_f32 v113, v113, v117
    v_add_f32 v106, v106, v110
    v_add_f32 v114, v114, v118
    v_add_f32 v107, v107, v111
    v_add_f32 v115, v115, v119
    v_add_f32 v104, v104, v112
    v_add_f32 v105, v105, v113
    v_add_f32 v106, v106, v114
    v_add_f32 v107, v107, v115
    v_fma_f32 v104, v68, v104, v24
    v_fma_f32 v105, v69, v105, v25
    v_fma_f32 v106, v70, v106, v26
    v_fma_f32 v107, v71, v107, v27
    v_cvt_pk_bf16_f32 v8, v104, v105
    v_cvt_pk_bf16_f32 v9, v106, v107
    buffer_store_dwordx2 v[8:9], v21, s[56:59], 0 offen
    s_cmp_lg_u32 s14, 0
    s_cbranch_scc1 L_exit
    v_mov_b32 v10, s9
    v_mov_b32 v11, 0
    s_mov_b64 exec, 1
    buffer_store_dword v10, v11, s[4:7], 0 offen
    s_branch L_exit
L_wrole:
    s_cmp_eq_u32 s99, 3
    s_cbranch_scc1 L_wst
    s_mov_b32 s48, s24
    s_mov_b32 s49, s25
    s_mov_b32 s50, 4718592
    s_mov_b32 s51, 0x20000
    v_lshrrev_b32 v8, 3, v1
    v_mul_u32_u24 v8, 1152, v8
    v_and_b32 v9, 7, v1
    v_lshl_add_u32 v8, v9, 4, v8
    s_lshl_b32 s72, s12, 2
    s_add_u32 s72, s72, s15
    s_mul_i32 s72, s72, 147456
    s_lshl_b32 s73, s77, 7
    s_add_u32 s72, s72, s73
    s_add_u32 m0, s101, 0
    s_nop 0
    buffer_load_dwordx4 v8, s[48:51], s72 offen nt lds
    s_add_u32 s72, s72, 9216
    s_add_u32 m0, s101, 1024
    s_nop 0
    buffer_load_dwordx4 v8, s[48:51], s72 offen nt lds
    s_add_u32 s72, s72, 9216
    s_add_u32 m0, s101, 2048
    s_nop 0
    buffer_load_dwordx4 v8, s[48:51], s72 offen nt lds
    s_add_u32 s72, s72, 9216
    s_add_u32 m0, s101, 3072
    s_nop 0
    buffer_load_dwordx4 v8, s[48:51], s72 offen nt lds
    s_add_u32 s72, s72, 9216
    s_waitcnt vmcnt(3)
    s_add_u32 m0, s101, 4096
    s_nop 0
    buffer_load_dwordx4 v8, s[48:51], s72 offen nt lds
    s_add_u32 s72, s72, 9216
    s_waitcnt vmcnt(3)
    s_add_u32 m0, s101, 5120
    s_nop 0
    buffer_load_dwordx4 v8, s[48:51], s72 offen nt lds
    s_add_u32 s72, s72, 9216
    s_waitcnt vmcnt(3)
    s_add_u32 m0, s101, 6144
    s_nop 0
    buffer_load_dwordx4 v8, s[48:51], s72 offen nt lds
    s_add_u32 s72, s72, 9216
    s_waitcnt vmcnt(3)
    s_add_u32 m0, s101, 7168
    s_nop 0
    buffer_load_dwordx4 v8, s[48:51], s72 offen nt lds
    s_add_u32 s72, s72, 9216
    s_waitcnt vmcnt(3)
    s_add_u32 m0, s101, 8192
    s_nop 0
    buffer_load_dwordx4 v8, s[48:51], s72 offen nt lds
    s_add_u32 s72, s72, 9216
    s_waitcnt vmcnt(3)
    s_add_u32 m0, s101, 9216
    s_nop 0
    buffer_load_dwordx4 v8, s[48:51], s72 offen nt lds
    s_add_u32 s72, s72, 9216
    s_waitcnt vmcnt(3)
    s_add_u32 m0, s101, 10240
    s_nop 0
    buffer_load_dwordx4 v8, s[48:51], s72 offen nt lds
    s_add_u32 s72, s72, 9216
    s_waitcnt vmcnt(3)
    s_add_u32 m0, s101, 11264
    s_nop 0
    buffer_load_dwordx4 v8, s[48:51], s72 offen nt lds
    s_add_u32 s72, s72, 9216
    s_waitcnt vmcnt(3)
    s_add_u32 m0, s101, 12288
    s_nop 0
    buffer_load_dwordx4 v8, s[48:51], s72 offen nt lds
    s_add_u32 s72, s72, 9216
    s_waitcnt vmcnt(3)
    s_add_u32 m0, s101, 13312
    s_nop 0
    buffer_load_dwordx4 v8, s[48:51], s72 offen nt lds
    s_add_u32 s72, s72, 9216
    s_waitcnt vmcnt(3)
    s_add_u32 m0, s101, 14336
    s_nop 0
    buffer_load_dwordx4 v8, s[48:51], s72 offen nt lds
    s_add_u32 s72, s72, 9216
    s_waitcnt vmcnt(3)
    s_add_u32 m0, s101, 15360
    s_nop 0
    buffer_load_dwordx4 v8, s[48:51], s72 offen nt lds
L_wst:
    v_lshrrev_b32 v8, 2, v3
    v_and_b32 v9, 3, v3
    v_lshl_add_u32 v10, v2, 3, v8
    v_lshlrev_b32 v10, 7, v10
    v_lshl_add_u32 v10, v9, 3, v10
    v_add_u32 v10, s101, v10
    s_waitcnt vmcnt(0)
    ds_read_b64_tr_b16 v[192:193], v10 offset:0
    ds_read_b64_tr_b16 v[194:195], v10 offset:512
    ds_read_b64_tr_b16 v[196:197], v10 offset:32
    ds_read_b64_tr_b16 v[198:199], v10 offset:544
    ds_read_b64_tr_b16 v[200:201], v10 offset:64
    ds_read_b64_tr_b16 v[202:203], v10 offset:576
    ds_read_b64_tr_b16 v[204:205], v10 offset:96
    ds_read_b64_tr_b16 v[206:207], v10 offset:608
    s_waitcnt lgkmcnt(0)
    ds_read_b64_tr_b16 v[208:209], v10 offset:4096
    ds_read_b64_tr_b16 v[210:211], v10 offset:4608
    ds_read_b64_tr_b16 v[212:213], v10 offset:4128
    ds_read_b64_tr_b16 v[214:215], v10 offset:4640
    ds_read_b64_tr_b16 v[216:217], v10 offset:4160
    ds_read_b64_tr_b16 v[218:219], v10 offset:4672
    ds_read_b64_tr_b16 v[220:221], v10 offset:4192
    ds_read_b64_tr_b16 v[222:223], v10 offset:4704
    s_waitcnt lgkmcnt(0)
    ds_read_b64_tr_b16 v[224:225], v10 offset:8192
    ds_read_b64_tr_b16 v[226:227], v10 offset:8704
    ds_read_b64_tr_b16 v[228:229], v10 offset:8224
    ds_read_b64_tr_b16 v[230:231], v10 offset:8736
    ds_read_b64_tr_b16 v[232:233], v10 offset:8256
    ds_read_b64_tr_b16 v[234:235], v10 offset:8768
    ds_read_b64_tr_b16 v[236:237], v10 offset:8288
    ds_read_b64_tr_b16 v[238:239], v10 offset:8800
    s_waitcnt lgkmcnt(0)
    ds_read_b64_tr_b16 v[240:241], v10 offset:12288
    ds_read_b64_tr_b16 v[242:243], v10 offset:12800
    ds_read_b64_tr_b16 v[244:245], v10 offset:12320
    ds_read_b64_tr_b16 v[246:247], v10 offset:12832
    ds_read_b64_tr_b16 v[248:249], v10 offset:12352
    ds_read_b64_tr_b16 v[250:251], v10 offset:12864
    ds_read_b64_tr_b16 v[252:253], v10 offset:12384
    ds_read_b64_tr_b16 v[254:255], v10 offset:12896
    s_waitcnt lgkmcnt(0)
    v_mov_b32 v12, 133440
L_wloc:
    ds_read_b32 v13, v12 offset:16
    s_waitcnt lgkmcnt(0)
    v_readfirstlane_b32 s22, v13
    s_nop 0
    s_cmp_ge_u32 s22, 30
    s_cbranch_scc1 L_wlocok
    s_sleep 64
    s_sub_u32 s66, s66, 1
    s_cmp_lg_u32 s66, 0
    s_cbranch_scc1 L_wloc
    s_branch L_exit
L_wlocok:
    v_and_b32 v58, 31, v1
    v_lshlrev_b32 v58, 3, v58
    s_lshl_b32 s22, s12, 8
    s_add_u32 s22, s22, 65536
    buffer_load_dwordx2 v[56:57], v58, s[4:7], s22 offen sc1
    s_waitcnt vmcnt(0)
    s_getreg_b32 s22, hwreg(HW_REG_XCC_ID)
    v_xor_b32 v56, s22, v56
    v_xor_b32 v57, s8, v57
    v_or_b32 v56, v56, v57
    v_cmp_ne_u32 vcc, 0, v56
    s_nop 0
    s_cmp_eq_u64 vcc, 0
    s_cselect_b32 s34, 1, 0
    v_mov_b32 v13, s34
    ds_write_b32 v12, v13 offset:28
    s_cmp_lt_u32 s77, 8
    s_cselect_b32 s76, 1, 0
    v_mov_b32 v108, 0
    v_mov_b32 v109, 0
    v_mov_b32 v110, 0
    v_mov_b32 v111, 0
    s_cbranch_scc0 L_wnor
    v_and_b32 v8, 1, v3
    v_lshlrev_b32 v8, 4, v8
    v_mov_b32 v9, 0x3f80
    v_lshlrev_b32 v9, v8, v9
    v_and_b32 v8, 2, v3
    v_cmp_eq_u32 vcc, 0, v8
    s_nop 1
    v_cndmask_b32 v10, 0, v9, vcc
    v_sub_u32 v11, v9, v10
    v_mov_b32 v92, 0
    v_mov_b32 v93, 0
    v_mov_b32 v94, 0
    v_mov_b32 v95, 0
    v_mov_b32 v96, 0
    v_mov_b32 v97, 0
    v_mov_b32 v98, 0
    v_mov_b32 v99, 0
    v_mov_b32 v100, 0
    v_mov_b32 v101, 0
    v_mov_b32 v102, 0
    v_mov_b32 v103, 0
    v_mov_b32_dpp v92, v10 quad_perm:[0,1,2,3] row_mask:0xf bank_mask:0x1
    v_mov_b32_dpp v94, v11 quad_perm:[0,1,2,3] row_mask:0xf bank_mask:0x1
    v_mov_b32_dpp v96, v10 quad_perm:[0,1,2,3] row_mask:0xf bank_mask:0x2
    v_mov_b32_dpp v98, v11 quad_perm:[0,1,2,3] row_mask:0xf bank_mask:0x2
    v_mov_b32_dpp v100, v10 quad_perm:[0,1,2,3] row_mask:0xf bank_mask:0x4
    v_mov_b32_dpp v102, v11 quad_perm:[0,1,2,3] row_mask:0xf bank_mask:0x4
    s_mul_i32 s35, s15, 5
    s_cmp_eq_u32 s15, 3
    s_cselect_b32 s35, 14, s35
    s_mov_b32 s28, -1
    s_cmp_lt_u32 s15, 2
    s_cselect_b32 s29, 0xff, 0
    s_cselect_b32 s63, 512, 0
    s_lshl_b32 s62, s35, 7
    v_lshlrev_b32 v109, 4, v1
    v_cndmask_b32 v109, 0, v109, s[28:29]
    v_add_u32 v109, s62, v109
    v_lshlrev_b32 v111, 3, v109
    v_mul_u32_u24 v8, 2304, v2
    v_add_u32 v8, s62, v8
    v_lshl_add_u32 v108, v3, 4, v8
    v_and_b32 v9, 7, v3
    v_lshl_add_u32 v110, v9, 4, v8
    v_add_u32 v110, s63, v110
    s_lshl_b32 s62, s77, 4
    s_add_u32 s62, s62, 167936
    s_add_u32 s63, s62, 18432
    s_add_u32 s65, s62, 36864
    s_mul_i32 s64, s77, 1152
    v_lshrrev_b32 v8, 1, v109
    buffer_load_dwordx2 v[88:89], v8, s[56:59], s64 offen
L_rmod:
    buffer_load_dwordx4 v[76:79], v111, s[4:7], s62 offen offset:0 sc1
    buffer_load_dwordx4 v[80:83], v111, s[4:7], s63 offen offset:0 sc1
    buffer_load_dwordx4 v[84:87], v111, s[4:7], s65 offen offset:0 sc1
    s_waitcnt vmcnt(0)
    v_bitop3_b32 v10, v77, v79, s8 bitop3:0x7e
    v_bitop3_b32 v11, v81, v83, s8 bitop3:0x7e
    v_bitop3_b32 v12, v85, v87, s8 bitop3:0x7e
    v_or3_b32 v10, v10, v11, v12
    v_cmp_ne_u32 vcc, 0, v10
    s_nop 0
    s_cbranch_vccz L_rmodok
    s_sleep 32
    s_sub_u32 s66, s66, 1
    s_cmp_lg_u32 s66, 0
    s_cbranch_scc1 L_rmod
    s_branch L_exit
L_rmodok:
    v_lshlrev_b32 v60, 16, v76
    v_and_b32 v61, s60, v76
    v_lshlrev_b32 v62, 16, v78
    v_and_b32 v63, s60, v78
    v_lshlrev_b32 v64, 16, v80
    v_and_b32 v65, s60, v80
    v_lshlrev_b32 v66, 16, v82
    v_and_b32 v67, s60, v82
    v_lshlrev_b32 v68, 16, v84
    v_and_b32 v69, s60, v84
    v_lshlrev_b32 v70, 16, v86
    v_and_b32 v71, s60, v86
    v_lshlrev_b32 v72, 16, v88
    v_and_b32 v73, s60, v88
    v_lshlrev_b32 v74, 16, v89
    v_and_b32 v75, s60, v89
    v_add_f32 v68, 1.0, v68
    v_add_f32 v69, 1.0, v69
    v_add_f32 v70, 1.0, v70
    v_add_f32 v71, 1.0, v71
    v_cvt_pk_bf16_f32 v8, v68, v69
    v_cvt_pk_bf16_f32 v9, v70, v71
    v_lshlrev_b32 v68, 16, v8
    v_and_b32 v69, s60, v8
    v_lshlrev_b32 v70, 16, v9
    v_and_b32 v71, s60, v9
    s_mul_i32 s74, s77, 18432
    s_add_u32 s74, s74, 1048576
    s_add_u32 s75, s74, 9216
    s_mul_i32 s62, s12, 18432
    s_lshl_b32 s72, s77, 4
    s_add_u32 s72, s72, s62
    s_add_u32 s72, s72, 1310720
    s_add_u32 s73, s72, 589824
    s_lshl_b32 s64, s15, 3
    s_add_u32 s64, s64, 133696
    v_mov_b32 v22, s64
    v_mov_b32 v23, 133696
    v_mov_b32 v25, s8
    v_mov_b32 v27, s8
    v_mov_b32 v29, s8
    v_mov_b32 v31, s8
    v_mov_b32 v28, 0
    v_mov_b32 v30, 0
    v_mov_b32 v128, 0
    v_mov_b32 v129, 0
    v_mov_b32 v130, 0
    v_mov_b32 v131, 0
    s_mov_b32 s33, 0x3c000000
    s_cmp_lt_u32 s15, 2
    s_cselect_b32 s33, 0x3bcccccd, s33
L_wnor:
    v_and_b32 v14, 7, v3
    v_mul_u32_u24 v14, 272, v14
    v_lshl_add_u32 v14, v2, 4, v14
    s_mul_i32 s62, s15, 2176
    s_add_u32 s62, s62, 118784
    v_add_u32 v14, s62, v14
    v_and_b32 v7, 1, v2
    v_lshl_add_u32 v7, s15, 1, v7
    v_mul_u32_u24 v15, 272, v7
    v_lshl_add_u32 v15, v3, 4, v15
    v_add_u32 v15, 118784, v15
    v_mul_u32_u24 v7, 18432, v7
    v_lshl_add_u32 v7, v3, 4, v7
    v_mov_b32 v17, s8
    v_mov_b32 v19, s8
    s_mov_b32 s68, 0xff00ff
    s_mov_b32 s69, 0xff00ff
    v_lshlrev_b32 v4, 4, v1
    s_lshl_b32 s62, s12, 2
    s_add_u32 s62, s62, s15
    s_lshl_b32 s62, s62, 13
    s_add_u32 s62, s62, 524288
    s_add_u32 s32, s62, 4096
    s_mul_i32 s63, s12, 2304
    s_lshl_b32 s64, s77, 8
    s_add_u32 s63, s63, s64
    s_add_u32 s63, s63, 1048576
    s_cmp_lg_u32 s15, 1
    s_cbranch_scc1 L_wbd
    v_mov_b32 v12, 133440
L_wkd:
    ds_read_b32 v13, v12 offset:32
    s_waitcnt lgkmcnt(0)
    v_readfirstlane_b32 s22, v13
    s_nop 0
    s_cmp_ge_u32 s22, 4
    s_cbranch_scc1 L_wkdok
    s_sleep 32
    s_sub_u32 s66, s66, 1
    s_cmp_lg_u32 s66, 0
    s_cbranch_scc1 L_wkd
    s_branch L_exit
L_wkdok:
    v_and_b32 v33, 1, v1
    v_lshlrev_b32 v33, 4, v33
    v_add_u32 v32, 133504, v33
    ds_read_b128 v[36:39], v32
    v_lshlrev_b32 v32, 3, v1
    v_add_u32 v32, 133888, v32
    s_mov_b32 s18, 16
    s_waitcnt lgkmcnt(0)
    v_max3_f32 v34, v36, v37, v38
    v_max_f32 v34, v34, v39
    v_mul_f32 v34, s61, v34
    v_mov_b32 v36, 0
L_wbl:
    ds_read2st64_b64 v[56:59], v32 offset0:0 offset1:1
    v_add_u32 v32, 1024, v32
    s_waitcnt lgkmcnt(0)
    v_lshlrev_b32 v38, 16, v56
    v_and_b32 v39, s60, v56
    v_fma_f32 v38, v38, s61, -v34
    v_fma_f32 v39, v39, s61, -v34
    v_exp_f32 v38, v38
    v_exp_f32 v39, v39
    v_add_f32 v36, v36, v38
    v_add_f32 v36, v36, v39
    v_lshlrev_b32 v38, 16, v57
    v_and_b32 v39, s60, v57
    v_fma_f32 v38, v38, s61, -v34
    v_fma_f32 v39, v39, s61, -v34
    v_exp_f32 v38, v38
    v_exp_f32 v39, v39
    v_add_f32 v36, v36, v38
    v_add_f32 v36, v36, v39
    v_lshlrev_b32 v38, 16, v58
    v_and_b32 v39, s60, v58
    v_fma_f32 v38, v38, s61, -v34
    v_fma_f32 v39, v39, s61, -v34
    v_exp_f32 v38, v38
    v_exp_f32 v39, v39
    v_add_f32 v36, v36, v38
    v_add_f32 v36, v36, v39
    v_lshlrev_b32 v38, 16, v59
    v_and_b32 v39, s60, v59
    v_fma_f32 v38, v38, s61, -v34
    v_fma_f32 v39, v39, s61, -v34
    v_exp_f32 v38, v38
    v_exp_f32 v39, v39
    v_add_f32 v36, v36, v38
    v_add_f32 v36, v36, v39
    s_sub_u32 s18, s18, 1
    s_cmp_lg_u32 s18, 0
    s_cbranch_scc1 L_wbl
    v_add_f32_dpp v36, v36, v36 quad_perm:[2,3,0,1] row_mask:0xf bank_mask:0xf
    s_nop 1
    v_add_f32_dpp v36, v36, v36 row_ror:4 row_mask:0xf bank_mask:0xf
    s_nop 1
    v_add_f32_dpp v36, v36, v36 row_ror:8 row_mask:0xf bank_mask:0xf
    v_mov_b32 v38, v36
    s_nop 1
    v_permlane16_swap_b32 v36, v38
    v_add_f32 v36, v36, v38
    v_mov_b32 v38, v36
    s_nop 1
    v_permlane32_swap_b32 v36, v38
    v_add_f32 v36, v36, v38
    v_mov_b32 v35, s8
    v_mov_b32 v37, s8
    s_lshl_b32 s20, s2, 7
    s_add_u32 s20, s20, 851968
    s_xor_b32 s21, s20, 1024
    s_mov_b64 exec, 3
    s_cmp_eq_u32 s34, 1
    s_cbranch_scc1 L_st_24a
    buffer_store_dwordx4 v[34:37], v33, s[4:7], s20 offen sc1
    s_branch L_st_24b
L_st_24a:
    buffer_store_dwordx4 v[34:37], v33, s[4:7], s20 offen
L_st_24b:
    v_mov_b32 v12, 133440
L_wxp:
    ds_read_b32 v13, v12 offset:16
    s_waitcnt lgkmcnt(0)
    v_readfirstlane_b32 s22, v13
    s_nop 0
    s_cmp_ge_u32 s22, 154
    s_cbranch_scc1 L_wxpok
    s_sleep 32
    s_sub_u32 s66, s66, 1
    s_cmp_lg_u32 s66, 0
    s_cbranch_scc1 L_wxp
    s_branch L_exit
L_wxpok:
L_wbalp:
    buffer_load_dwordx4 v[56:59], v33, s[4:7], s21 offen offset:0 sc1
    s_waitcnt vmcnt(0)
    v_bitop3_b32 v38, v57, v59, s8 bitop3:0x7e
    v_cmp_ne_u32 vcc, 0, v38
    s_nop 0
    s_cbranch_vccz L_wbalpok
    s_sleep 16
    s_sub_u32 s66, s66, 1
    s_cmp_lg_u32 s66, 0
    s_cbranch_scc1 L_wbalp
    s_branch L_exit
L_wbalpok:
    v_max_f32 v38, v34, v56
    v_sub_f32 v34, v34, v38
    v_sub_f32 v56, v56, v38
    v_exp_f32 v34, v34
    v_exp_f32 v56, v56
    v_mul_f32 v36, v36, v34
    v_fmac_f32 v36, v58, v56
    v_rcp_f32 v36, v36
    v_mov_b32 v35, 1
    v_mul_f32 v34, v34, v36
    v_lshrrev_b32 v33, 1, v33
    v_add_u32 v33, 133488, v33
    ds_write_b64 v33, v[34:35]
    s_waitcnt lgkmcnt(0)
    s_mov_b64 exec, -1
L_wbd:
    s_cmp_lg_u32 s15, 2
    s_cbranch_scc1 L_wpd
    v_mov_b32 v32, 133440
    v_and_b32 v33, 7, v1
    v_mul_u32_u24 v33, 4352, v33
    v_mov_b32 v35, s8
    s_lshr_b32 s18, s2, 5
    s_mul_i32 s18, s18, 5
    s_add_u32 s18, s18, s2
    s_and_b32 s19, s18, 31
    s_lshr_b32 s18, s2, 5
    s_mul_i32 s18, s18, 4352
    s_cmp_eq_u32 s19, 0
    s_cselect_b32 s18, s18, 0x7ff00000
    v_mov_b32 v12, 133440
L_wc0u:
    ds_read_b32 v13, v12 offset:16
    s_waitcnt lgkmcnt(0)
    v_readfirstlane_b32 s22, v13
    s_nop 0
    s_cmp_ge_u32 s22, 46
    s_cbranch_scc1 L_wc0uok
    s_sleep 32
    s_sub_u32 s66, s66, 1
    s_cmp_lg_u32 s66, 0
    s_cbranch_scc1 L_wc0u
    s_branch L_exit
L_wc0uok:
    v_mov_b32 v12, 133440
L_wc0v:
    ds_read_b32 v13, v12 offset:16
    s_waitcnt lgkmcnt(0)
    v_readfirstlane_b32 s22, v13
    s_nop 0
    s_cmp_ge_u32 s22, 52
    s_cbranch_scc1 L_wc0vok
    s_sleep 2
    s_sub_u32 s66, s66, 1
    s_cmp_lg_u32 s66, 0
    s_cbranch_scc1 L_wc0v
    s_branch L_exit
L_wc0vok:
    s_memrealtime s[20:21]
    s_add_u32 s19, s18, 1572864
    s_waitcnt lgkmcnt(0)
    v_mov_b32 v34, s20
    s_mov_b64 exec, 1
    buffer_store_dwordx2 v[34:35], off, s[4:7], s19 sc1
    s_mov_b64 exec, -1
    v_mov_b32 v12, 133440
L_wc0w:
    ds_read_b32 v13, v12 offset:16
    s_waitcnt lgkmcnt(0)
    v_readfirstlane_b32 s22, v13
    s_nop 0
    s_cmp_ge_u32 s22, 64
    s_cbranch_scc1 L_wc0wok
    s_sleep 16
    s_sub_u32 s66, s66, 1
    s_cmp_lg_u32 s66, 0
    s_cbranch_scc1 L_wc0w
    s_branch L_exit
L_wc0wok:
    s_mov_b32 s19, 1572864
    buffer_load_dwordx2 v[36:37], v33, s[4:7], s19 offen sc1
    s_waitcnt vmcnt(0)
    ds_read_b32 v38, v32 offset:16
    v_sub_u32 v36, v34, v36
    v_mov_b32 v39, -336
    v_cmp_eq_u32 vcc, v35, v37
    s_nop 1
    v_cndmask_b32 v36, v39, v36, vcc
    v_cvt_f32_i32 v36, v36
    s_nop 1
    v_add_f32_dpp v36, v36, v36 quad_perm:[1,0,3,2] row_mask:0xf bank_mask:0xf
    s_nop 1
    v_add_f32_dpp v36, v36, v36 quad_perm:[2,3,0,1] row_mask:0xf bank_mask:0xf
    s_nop 1
    v_add_f32_dpp v36, v36, v36 row_half_mirror row_mask:0xf bank_mask:0xf
    s_nop 1
    v_add_f32_dpp v36, v36, v36 row_mirror row_mask:0xf bank_mask:0xf
    v_mov_b32 v39, v36
    s_nop 1
    v_permlane16_swap_b32 v36, v39
    v_add_f32 v36, v36, v39
    v_mov_b32 v39, v36
    s_nop 1
    v_permlane32_swap_b32 v36, v39
    v_add_f32 v36, v36, v39
    v_mov_b32 v39, 0x40800000
    v_fmac_f32 v39, 0x3b1467e2, v36
    v_max_f32 v39, 0, v39
    v_min_f32 v39, 0x42800000, v39
    v_cvt_u32_f32 v39, v39
    s_waitcnt lgkmcnt(0)
    v_add3_u32 v38, v38, v39, 40
    ds_write_b32 v32, v38 offset:12
    s_waitcnt lgkmcnt(0)
    v_mov_b32 v56, v34
    v_mov_b32 v57, v36
    v_mov_b32 v12, 133440
L_wc1u:
    ds_read_b32 v13, v12 offset:16
    s_waitcnt lgkmcnt(0)
    v_readfirstlane_b32 s22, v13
    s_nop 0
    s_cmp_ge_u32 s22, 106
    s_cbranch_scc1 L_wc1uok
    s_sleep 32
    s_sub_u32 s66, s66, 1
    s_cmp_lg_u32 s66, 0
    s_cbranch_scc1 L_wc1u
    s_branch L_exit
L_wc1uok:
    v_mov_b32 v12, 133440
L_wc1v:
    ds_read_b32 v13, v12 offset:16
    s_waitcnt lgkmcnt(0)
    v_readfirstlane_b32 s22, v13
    s_nop 0
    s_cmp_ge_u32 s22, 112
    s_cbranch_scc1 L_wc1vok
    s_sleep 2
    s_sub_u32 s66, s66, 1
    s_cmp_lg_u32 s66, 0
    s_cbranch_scc1 L_wc1v
    s_branch L_exit
L_wc1vok:
    s_memrealtime s[20:21]
    s_add_u32 s19, s18, 1572992
    s_waitcnt lgkmcnt(0)
    v_mov_b32 v34, s20
    s_mov_b64 exec, 1
    buffer_store_dwordx2 v[34:35], off, s[4:7], s19 sc1
    s_mov_b64 exec, -1
    v_mov_b32 v12, 133440
L_wc1w:
    ds_read_b32 v13, v12 offset:16
    s_waitcnt lgkmcnt(0)
    v_readfirstlane_b32 s22, v13
    s_nop 0
    s_cmp_ge_u32 s22, 124
    s_cbranch_scc1 L_wc1wok
    s_sleep 16
    s_sub_u32 s66, s66, 1
    s_cmp_lg_u32 s66, 0
    s_cbranch_scc1 L_wc1w
    s_branch L_exit
L_wc1wok:
    s_mov_b32 s19, 1572992
    buffer_load_dwordx2 v[36:37], v33, s[4:7], s19 offen sc1
    s_waitcnt vmcnt(0)
    ds_read_b32 v38, v32 offset:16
    v_sub_u32 v36, v34, v36
    v_mov_b32 v39, -336
    v_cmp_eq_u32 vcc, v35, v37
    s_nop 1
    v_cndmask_b32 v36, v39, v36, vcc
    v_cvt_f32_i32 v36, v36
    s_nop 1
    v_add_f32_dpp v36, v36, v36 quad_perm:[1,0,3,2] row_mask:0xf bank_mask:0xf
    s_nop 1
    v_add_f32_dpp v36, v36, v36 quad_perm:[2,3,0,1] row_mask:0xf bank_mask:0xf
    s_nop 1
    v_add_f32_dpp v36, v36, v36 row_half_mirror row_mask:0xf bank_mask:0xf
    s_nop 1
    v_add_f32_dpp v36, v36, v36 row_mirror row_mask:0xf bank_mask:0xf
    v_mov_b32 v39, v36
    s_nop 1
    v_permlane16_swap_b32 v36, v39
    v_add_f32 v36, v36, v39
    v_mov_b32 v39, v36
    s_nop 1
    v_permlane32_swap_b32 v36, v39
    v_add_f32 v36, v36, v39
    v_mov_b32 v39, 0x40800000
    v_fmac_f32 v39, 0x3b1467e2, v36
    v_max_f32 v39, 0, v39
    v_min_f32 v39, 0x42800000, v39
    v_cvt_u32_f32 v39, v39
    s_waitcnt lgkmcnt(0)
    v_add3_u32 v38, v38, v39, 40
    ds_write_b32 v32, v38 offset:12
    s_waitcnt lgkmcnt(0)
    v_mov_b32 v56, v34
    v_mov_b32 v57, v36
    v_mov_b32 v12, 133440
L_wc2u:
    ds_read_b32 v13, v12 offset:16
    s_waitcnt lgkmcnt(0)
    v_readfirstlane_b32 s22, v13
    s_nop 0
    s_cmp_ge_u32 s22, 151
    s_cbranch_scc1 L_wc2uok
    s_sleep 32
    s_sub_u32 s66, s66, 1
    s_cmp_lg_u32 s66, 0
    s_cbranch_scc1 L_wc2u
    s_branch L_exit
L_wc2uok:
    v_mov_b32 v12, 133440
L_wc2v:
    ds_read_b32 v13, v12 offset:16
    s_waitcnt lgkmcnt(0)
    v_readfirstlane_b32 s22, v13
    s_nop 0
    s_cmp_ge_u32 s22, 157
    s_cbranch_scc1 L_wc2vok
    s_sleep 2
    s_sub_u32 s66, s66, 1
    s_cmp_lg_u32 s66, 0
    s_cbranch_scc1 L_wc2v
    s_branch L_exit
L_wc2vok:
    s_memrealtime s[20:21]
    s_add_u32 s19, s18, 1573120
    s_waitcnt lgkmcnt(0)
    v_mov_b32 v34, s20
    s_mov_b64 exec, 1
    buffer_store_dwordx2 v[34:35], off, s[4:7], s19 sc1
    s_mov_b64 exec, -1
    v_mov_b32 v12, 133440
L_wc2w:
    ds_read_b32 v13, v12 offset:16
    s_waitcnt lgkmcnt(0)
    v_readfirstlane_b32 s22, v13
    s_nop 0
    s_cmp_ge_u32 s22, 169
    s_cbranch_scc1 L_wc2wok
    s_sleep 16
    s_sub_u32 s66, s66, 1
    s_cmp_lg_u32 s66, 0
    s_cbranch_scc1 L_wc2w
    s_branch L_exit
L_wc2wok:
    s_mov_b32 s19, 1573120
    buffer_load_dwordx2 v[36:37], v33, s[4:7], s19 offen sc1
    s_waitcnt vmcnt(0)
    ds_read_b32 v38, v32 offset:16
    v_sub_u32 v36, v34, v36
    v_mov_b32 v39, -336
    v_cmp_eq_u32 vcc, v35, v37
    s_nop 1
    v_cndmask_b32 v36, v39, v36, vcc
    v_cvt_f32_i32 v36, v36
    s_nop 1
    v_add_f32_dpp v36, v36, v36 quad_perm:[1,0,3,2] row_mask:0xf bank_mask:0xf
    s_nop 1
    v_add_f32_dpp v36, v36, v36 quad_perm:[2,3,0,1] row_mask:0xf bank_mask:0xf
    s_nop 1
    v_add_f32_dpp v36, v36, v36 row_half_mirror row_mask:0xf bank_mask:0xf
    s_nop 1
    v_add_f32_dpp v36, v36, v36 row_mirror row_mask:0xf bank_mask:0xf
    v_mov_b32 v39, v36
    s_nop 1
    v_permlane16_swap_b32 v36, v39
    v_add_f32 v36, v36, v39
    v_mov_b32 v39, v36
    s_nop 1
    v_permlane32_swap_b32 v36, v39
    v_add_f32 v36, v36, v39
    v_mov_b32 v39, 0x40800000
    v_fmac_f32 v39, 0x3b1467e2, v36
    v_max_f32 v39, 0, v39
    v_min_f32 v39, 0x42800000, v39
    v_cvt_u32_f32 v39, v39
    s_waitcnt lgkmcnt(0)
    v_add3_u32 v38, v38, v39, 40
    ds_write_b32 v32, v38 offset:12
    s_waitcnt lgkmcnt(0)
    v_mov_b32 v56, v34
    v_mov_b32 v57, v36
    v_mov_b32 v12, 133440
L_wc3u:
    ds_read_b32 v13, v12 offset:16
    s_waitcnt lgkmcnt(0)
    v_readfirstlane_b32 s22, v13
    s_nop 0
    s_cmp_ge_u32 s22, 178
    s_cbranch_scc1 L_wc3uok
    s_sleep 32
    s_sub_u32 s66, s66, 1
    s_cmp_lg_u32 s66, 0
    s_cbranch_scc1 L_wc3u
    s_branch L_exit
L_wc3uok:
    v_mov_b32 v12, 133440
L_wc3v:
    ds_read_b32 v13, v12 offset:16
    s_waitcnt lgkmcnt(0)
    v_readfirstlane_b32 s22, v13
    s_nop 0
    s_cmp_ge_u32 s22, 184
    s_cbranch_scc1 L_wc3vok
    s_sleep 2
    s_sub_u32 s66, s66, 1
    s_cmp_lg_u32 s66, 0
    s_cbranch_scc1 L_wc3v
    s_branch L_exit
L_wc3vok:
    s_memrealtime s[20:21]
    s_add_u32 s19, s18, 1573248
    s_waitcnt lgkmcnt(0)
    v_mov_b32 v34, s20
    s_mov_b64 exec, 1
    buffer_store_dwordx2 v[34:35], off, s[4:7], s19 sc1
    s_mov_b64 exec, -1
    v_mov_b32 v12, 133440
L_wc3w:
    ds_read_b32 v13, v12 offset:16
    s_waitcnt lgkmcnt(0)
    v_readfirstlane_b32 s22, v13
    s_nop 0
    s_cmp_ge_u32 s22, 196
    s_cbranch_scc1 L_wc3wok
    s_sleep 16
    s_sub_u32 s66, s66, 1
    s_cmp_lg_u32 s66, 0
    s_cbranch_scc1 L_wc3w
    s_branch L_exit
L_wc3wok:
    s_mov_b32 s19, 1573248
    buffer_load_dwordx2 v[36:37], v33, s[4:7], s19 offen sc1
    s_waitcnt vmcnt(0)
    ds_read_b32 v38, v32 offset:16
    v_sub_u32 v36, v34, v36
    v_mov_b32 v39, -336
    v_cmp_eq_u32 vcc, v35, v37
    s_nop 1
    v_cndmask_b32 v36, v39, v36, vcc
    v_cvt_f32_i32 v36, v36
    s_nop 1
    v_add_f32_dpp v36, v36, v36 quad_perm:[1,0,3,2] row_mask:0xf bank_mask:0xf
    s_nop 1
    v_add_f32_dpp v36, v36, v36 quad_perm:[2,3,0,1] row_mask:0xf bank_mask:0xf
    s_nop 1
    v_add_f32_dpp v36, v36, v36 row_half_mirror row_mask:0xf bank_mask:0xf
    s_nop 1
    v_add_f32_dpp v36, v36, v36 row_mirror row_mask:0xf bank_mask:0xf
    v_mov_b32 v39, v36
    s_nop 1
    v_permlane16_swap_b32 v36, v39
    v_add_f32 v36, v36, v39
    v_mov_b32 v39, v36
    s_nop 1
    v_permlane32_swap_b32 v36, v39
    v_add_f32 v36, v36, v39
    v_sub_u32 v56, v34, v56
    v_cvt_f32_i32 v56, v56
    v_sub_f32 v57, v57, v36
    v_fmac_f32 v56, 0x3c800000, v57
    v_rcp_f32 v56, v56
    v_mul_f32 v36, 0x3c800000, v36
    v_mul_f32 v56, 0x41d80000, v56
    s_memrealtime s[20:21]
    ds_read_b32 v38, v32 offset:16
    s_waitcnt lgkmcnt(0)
    v_sub_u32 v39, s20, v34
    v_cvt_f32_i32 v39, v39
    v_add_f32 v39, v39, v36
    v_cvt_f32_u32 v58, v38
    v_subrev_f32 v58, 0x43390000, v58
    v_fma_f32 v39, v39, v56, -v58
    v_mul_f32 v39, 0x40800000, v39
    v_max_f32 v39, 0, v39
    v_min_f32 v39, 0x42800000, v39
    v_cvt_u32_f32 v39, v39
    v_add3_u32 v38, v38, v39, 40
    ds_write_b32 v32, v38 offset:12
    s_waitcnt lgkmcnt(0)
L_wpd:
    v_mov_b32 v40, 0
    v_mov_b32 v41, 0
    v_mov_b32 v42, 0
    v_mov_b32 v43, 0
    v_mov_b32 v44, 0
    v_mov_b32 v45, 0
    v_mov_b32 v46, 0
    v_mov_b32 v47, 0
    v_mov_b32 v48, 0
    v_mov_b32 v49, 0
    v_mov_b32 v50, 0
    v_mov_b32 v51, 0
    v_mov_b32 v52, 0
    v_mov_b32 v53, 0
    v_mov_b32 v54, 0
    v_mov_b32 v55, 0
    v_mov_b32 v112, 0
    v_mov_b32 v113, 0
    v_mov_b32 v114, 0
    v_mov_b32 v115, 0
    v_mov_b32 v116, 0
    v_mov_b32 v117, 0
    v_mov_b32 v118, 0
    v_mov_b32 v119, 0
    v_mov_b32 v120, 0
    v_mov_b32 v121, 0
    v_mov_b32 v122, 0
    v_mov_b32 v123, 0
    v_mov_b32 v124, 0
    v_mov_b32 v125, 0
    v_mov_b32 v126, 0
    v_mov_b32 v127, 0
    v_mov_b32 v12, 133440
L_wpub:
    ds_read_b32 v13, v12 offset:20
    s_waitcnt lgkmcnt(0)
    v_readfirstlane_b32 s22, v13
    s_nop 0
    s_cmp_ge_u32 s22, 1
    s_cbranch_scc1 L_wpubok
    s_sleep 1
    s_sub_u32 s66, s66, 1
    s_cmp_lg_u32 s66, 0
    s_cbranch_scc1 L_wpub
    s_branch L_exit
L_wpubok:
    buffer_load_dwordx4 v[160:163], v4, s[4:7], s62 offen offset:0 sc1
    buffer_load_dwordx4 v[164:167], v4, s[4:7], s62 offen offset:1024 sc1
    buffer_load_dwordx4 v[168:171], v4, s[4:7], s62 offen offset:2048 sc1
    buffer_load_dwordx4 v[172:175], v4, s[4:7], s62 offen offset:3072 sc1
    buffer_load_dwordx4 v[176:179], v4, s[4:7], s32 offen offset:0 sc1
    buffer_load_dwordx4 v[180:183], v4, s[4:7], s32 offen offset:1024 sc1
    buffer_load_dwordx4 v[184:187], v4, s[4:7], s32 offen offset:2048 sc1
    buffer_load_dwordx4 v[188:191], v4, s[4:7], s32 offen offset:3072 sc1
L_op:
    s_waitcnt vmcnt(0)
    v_bitop3_b32 v12, v161, v163, s8 bitop3:0x7e
    v_bitop3_b32 v10, v165, v167, s8 bitop3:0x7e
    v_bitop3_b32 v11, v169, v171, s8 bitop3:0x7e
    v_or3_b32 v12, v12, v10, v11
    v_bitop3_b32 v10, v173, v175, s8 bitop3:0x7e
    v_bitop3_b32 v11, v177, v179, s8 bitop3:0x7e
    v_or3_b32 v12, v12, v10, v11
    v_bitop3_b32 v10, v181, v183, s8 bitop3:0x7e
    v_bitop3_b32 v11, v185, v187, s8 bitop3:0x7e
    v_or3_b32 v12, v12, v10, v11
    v_bitop3_b32 v10, v189, v191, s8 bitop3:0x7e
    v_or_b32 v12, v12, v10
    v_cmp_ne_u32 vcc, 0, v12
    s_nop 0
    s_cbranch_vccz L_opok
    s_mov_b64 exec, vcc
    buffer_load_dwordx4 v[160:163], v4, s[4:7], s62 offen offset:0 sc1
    buffer_load_dwordx4 v[164:167], v4, s[4:7], s62 offen offset:1024 sc1
    buffer_load_dwordx4 v[168:171], v4, s[4:7], s62 offen offset:2048 sc1
    buffer_load_dwordx4 v[172:175], v4, s[4:7], s62 offen offset:3072 sc1
    buffer_load_dwordx4 v[176:179], v4, s[4:7], s32 offen offset:0 sc1
    buffer_load_dwordx4 v[180:183], v4, s[4:7], s32 offen offset:1024 sc1
    buffer_load_dwordx4 v[184:187], v4, s[4:7], s32 offen offset:2048 sc1
    buffer_load_dwordx4 v[188:191], v4, s[4:7], s32 offen offset:3072 sc1
    s_sub_u32 s66, s66, 1
    s_cmp_lg_u32 s66, 0
    s_cbranch_scc1 L_op
    s_branch L_exit
L_opok:
    s_mov_b64 exec, -1
    v_mov_b32 v161, v162
    v_mov_b32 v162, v164
    v_mov_b32 v163, v166
    s_nop 1
    v_mfma_f32_16x16x32_bf16 v[40:43], v[192:195], v[160:163], 0
    v_mov_b32 v169, v170
    v_mov_b32 v170, v172
    v_mov_b32 v171, v174
    v_mfma_f32_16x16x32_bf16 v[44:47], v[196:199], v[160:163], 0
    v_mfma_f32_16x16x32_bf16 v[48:51], v[200:203], v[160:163], 0
    v_mfma_f32_16x16x32_bf16 v[52:55], v[204:207], v[160:163], 0
    v_mfma_f32_16x16x32_bf16 v[40:43], v[208:211], v[168:171], v[40:43]
    v_mov_b32 v177, v178
    v_mov_b32 v178, v180
    v_mov_b32 v179, v182
    v_mfma_f32_16x16x32_bf16 v[44:47], v[212:215], v[168:171], v[44:47]
    v_mfma_f32_16x16x32_bf16 v[48:51], v[216:219], v[168:171], v[48:51]
    v_mfma_f32_16x16x32_bf16 v[52:55], v[220:223], v[168:171], v[52:55]
    v_mfma_f32_16x16x32_bf16 v[40:43], v[224:227], v[176:179], v[40:43]
    v_mov_b32 v185, v186
    v_mov_b32 v186, v188
    v_mov_b32 v187, v190
    v_mfma_f32_16x16x32_bf16 v[44:47], v[228:231], v[176:179], v[44:47]
    v_mfma_f32_16x16x32_bf16 v[48:51], v[232:235], v[176:179], v[48:51]
    v_mfma_f32_16x16x32_bf16 v[52:55], v[236:239], v[176:179], v[52:55]
    v_mfma_f32_16x16x32_bf16 v[40:43], v[240:243], v[184:187], v[40:43]
    v_mfma_f32_16x16x32_bf16 v[44:47], v[244:247], v[184:187], v[44:47]
    v_mfma_f32_16x16x32_bf16 v[48:51], v[248:251], v[184:187], v[48:51]
    v_mfma_f32_16x16x32_bf16 v[52:55], v[252:255], v[184:187], v[52:55]
    s_nop 4
    v_add_f32_dpp v40, v40, v40 row_ror:8 row_mask:0xf bank_mask:0xf
    v_add_f32_dpp v41, v41, v41 row_ror:8 row_mask:0xf bank_mask:0xf
    v_add_f32_dpp v42, v42, v42 row_ror:8 row_mask:0xf bank_mask:0xf
    v_add_f32_dpp v43, v43, v43 row_ror:8 row_mask:0xf bank_mask:0xf
    v_add_f32_dpp v44, v44, v44 row_ror:8 row_mask:0xf bank_mask:0xf
    v_add_f32_dpp v45, v45, v45 row_ror:8 row_mask:0xf bank_mask:0xf
    v_add_f32_dpp v46, v46, v46 row_ror:8 row_mask:0xf bank_mask:0xf
    v_add_f32_dpp v47, v47, v47 row_ror:8 row_mask:0xf bank_mask:0xf
    v_add_f32_dpp v48, v48, v48 row_ror:8 row_mask:0xf bank_mask:0xf
    v_add_f32_dpp v49, v49, v49 row_ror:8 row_mask:0xf bank_mask:0xf
    v_add_f32_dpp v50, v50, v50 row_ror:8 row_mask:0xf bank_mask:0xf
    v_add_f32_dpp v51, v51, v51 row_ror:8 row_mask:0xf bank_mask:0xf
    v_add_f32_dpp v52, v52, v52 row_ror:8 row_mask:0xf bank_mask:0xf
    v_add_f32_dpp v53, v53, v53 row_ror:8 row_mask:0xf bank_mask:0xf
    v_add_f32_dpp v54, v54, v54 row_ror:8 row_mask:0xf bank_mask:0xf
    v_add_f32_dpp v55, v55, v55 row_ror:8 row_mask:0xf bank_mask:0xf
    s_mov_b64 exec, s[68:69]
    ds_write_b128 v14, v[40:43] offset:0
    ds_write_b128 v14, v[44:47] offset:64
    ds_write_b128 v14, v[48:51] offset:128
    ds_write_b128 v14, v[52:55] offset:192
    s_mov_b64 exec, -1
    s_waitcnt lgkmcnt(0)
    s_barrier
    ds_read_b128 v[140:143], v15 offset:0
    ds_read_b128 v[144:147], v15 offset:2176
    ds_read_b128 v[148:151], v15 offset:4352
    ds_read_b128 v[152:155], v15 offset:6528
    s_waitcnt lgkmcnt(0)
    v_add_f32 v140, v140, v144
    v_add_f32 v148, v148, v152
    v_add_f32 v141, v141, v145
    v_add_f32 v149, v149, v153
    v_add_f32 v142, v142, v146
    v_add_f32 v150, v150, v154
    v_add_f32 v143, v143, v147
    v_add_f32 v151, v151, v155
    v_add_f32 v140, v140, v148
    v_add_f32 v141, v141, v149
    v_add_f32 v142, v142, v150
    v_add_f32 v143, v143, v151
    v_cvt_pk_bf16_f32 v16, v140, v141
    v_cvt_pk_bf16_f32 v18, v142, v143
    s_mov_b32 exec_hi, 0
    buffer_store_dwordx4 v[16:19], v7, s[4:7], s63 offen sc1
    s_mov_b64 exec, -1
    s_cmp_eq_u32 s76, 0
    s_cbranch_scc1 L_exit
    s_waitcnt vmcnt(0)
    buffer_load_dwordx4 v[160:163], v108, s[4:7], s74 offen offset:0 sc1
    buffer_load_dwordx4 v[164:167], v108, s[4:7], s74 offen offset:256 sc1
    buffer_load_dwordx4 v[168:171], v110, s[4:7], s74 offen offset:0 sc1
    buffer_load_dwordx4 v[172:175], v108, s[4:7], s75 offen offset:0 sc1
    buffer_load_dwordx4 v[176:179], v108, s[4:7], s75 offen offset:256 sc1
    buffer_load_dwordx4 v[180:183], v110, s[4:7], s75 offen offset:0 sc1
L_ap:
    s_waitcnt vmcnt(0)
    v_bitop3_b32 v12, v161, v163, s8 bitop3:0x7e
    v_bitop3_b32 v10, v165, v167, s8 bitop3:0x7e
    v_bitop3_b32 v11, v169, v171, s8 bitop3:0x7e
    v_or3_b32 v12, v12, v10, v11
    v_bitop3_b32 v10, v173, v175, s8 bitop3:0x7e
    v_bitop3_b32 v11, v177, v179, s8 bitop3:0x7e
    v_or3_b32 v12, v12, v10, v11
    v_bitop3_b32 v10, v181, v183, s8 bitop3:0x7e
    v_or_b32 v12, v12, v10
    v_cmp_ne_u32 vcc, 0, v12
    s_nop 0
    s_cbranch_vccz L_apok
    s_mov_b64 exec, vcc
    buffer_load_dwordx4 v[160:163], v108, s[4:7], s74 offen offset:0 sc1
    buffer_load_dwordx4 v[164:167], v108, s[4:7], s74 offen offset:256 sc1
    buffer_load_dwordx4 v[168:171], v110, s[4:7], s74 offen offset:0 sc1
    buffer_load_dwordx4 v[172:175], v108, s[4:7], s75 offen offset:0 sc1
    buffer_load_dwordx4 v[176:179], v108, s[4:7], s75 offen offset:256 sc1
    buffer_load_dwordx4 v[180:183], v110, s[4:7], s75 offen offset:0 sc1
    s_sub_u32 s66, s66, 1
    s_cmp_lg_u32 s66, 0
    s_cbranch_scc1 L_ap
    s_branch L_exit
L_apok:
    s_mov_b64 exec, -1
    v_mfma_f32_16x16x32_bf16 v[128:131], v[92:95], v[160:163], v[128:131]
    v_mfma_f32_16x16x32_bf16 v[128:131], v[96:99], v[164:167], v[128:131]
    v_mfma_f32_16x16x32_bf16 v[128:131], v[100:103], v[168:171], v[128:131]
    v_mfma_f32_16x16x32_bf16 v[128:131], v[92:95], v[172:175], v[128:131]
    v_mfma_f32_16x16x32_bf16 v[128:131], v[96:99], v[176:179], v[128:131]
    v_mfma_f32_16x16x32_bf16 v[128:131], v[100:103], v[180:183], v[128:131]
    s_nop 7
    v_fma_f32 v128, v60, v128, v72
    v_fma_f32 v129, v61, v129, v73
    v_fma_f32 v130, v62, v130, v74
    v_fma_f32 v131, v63, v131, v75
    v_readfirstlane_b32 s64, v128
    s_nop 1
    v_subrev_f32 v12, s64, v128
    v_subrev_f32 v13, s64, v129
    v_subrev_f32 v14, s64, v130
    v_subrev_f32 v15, s64, v131
    v_add_f32 v8, v12, v13
    v_mul_f32 v9, v12, v12
    v_add_f32 v10, v14, v15
    v_fmac_f32 v9, v13, v13
    v_add_f32 v8, v8, v10
    v_fmac_f32 v9, v14, v14
    v_fmac_f32 v9, v15, v15
    v_cndmask_b32 v8, 0, v8, s[28:29]
    v_cndmask_b32 v9, 0, v9, s[28:29]
    s_nop 0
    v_add_f32_dpp v8, v8, v8 row_shr:1 row_mask:0xf bank_mask:0xf bound_ctrl:0
    v_add_f32_dpp v9, v9, v9 row_shr:1 row_mask:0xf bank_mask:0xf bound_ctrl:0
    s_nop 0
    v_add_f32_dpp v8, v8, v8 row_shr:2 row_mask:0xf bank_mask:0xf bound_ctrl:0
    v_add_f32_dpp v9, v9, v9 row_shr:2 row_mask:0xf bank_mask:0xf bound_ctrl:0
    s_nop 0
    v_add_f32_dpp v8, v8, v8 row_shr:4 row_mask:0xf bank_mask:0xf bound_ctrl:0
    v_add_f32_dpp v9, v9, v9 row_shr:4 row_mask:0xf bank_mask:0xf bound_ctrl:0
    s_nop 0
    v_add_f32_dpp v8, v8, v8 row_shr:8 row_mask:0xf bank_mask:0xf bound_ctrl:0
    v_add_f32_dpp v9, v9, v9 row_shr:8 row_mask:0xf bank_mask:0xf bound_ctrl:0
    s_nop 0
    v_add_f32_dpp v8, v8, v8 row_bcast:15 row_mask:0xa bank_mask:0xf
    v_add_f32_dpp v9, v9, v9 row_bcast:15 row_mask:0xa bank_mask:0xf
    s_nop 0
    v_add_f32_dpp v8, v8, v8 row_bcast:31 row_mask:0xc bank_mask:0xf
    v_add_f32_dpp v9, v9, v9 row_bcast:31 row_mask:0xc bank_mask:0xf
    v_mul_f32 v10, s33, v8
    v_fma_f32 v9, -v10, v8, v9
    v_add_f32 v8, s64, v10
    s_mov_b32 exec_lo, 0
    s_mov_b32 exec_hi, 0x8000
    ds_write_b64 v22, v[8:9]
    s_mov_b64 exec, -1
    v_cvt_pk_bf16_f32 v24, v128, v129
    v_cvt_pk_bf16_f32 v26, v130, v131
    s_waitcnt lgkmcnt(0)
    s_barrier
    ds_read_b128 v[40:43], v23
    ds_read_b128 v[44:47], v23 offset:16
    s_waitcnt lgkmcnt(0)
    v_add_f32 v8, v40, v42
    v_add_f32 v9, v44, v46
    v_add_f32 v10, v41, v43
    v_add_f32 v11, v45, v47
    v_mul_f32 v8, 0x3e8e38e4, v8
    v_add_f32 v10, v10, v11
    v_fmac_f32 v8, 0x3e638e39, v9
    v_mul_f32 v10, 0x3ae38e39, v10
    v_sub_f32 v40, v40, v8
    v_sub_f32 v42, v42, v8
    v_sub_f32 v44, v44, v8
    v_sub_f32 v46, v46, v8
    v_mul_f32 v9, v40, v40
    v_mul_f32 v11, v44, v44
    v_fmac_f32 v9, v42, v42
    v_fmac_f32 v11, v46, v46
    v_fmac_f32 v10, 0x3e8e38e4, v9
    v_fmac_f32 v10, 0x3e638e39, v11
    v_max_f32 v10, 0, v10
    v_add_f32 v10, 0x3727c5ac, v10
    v_rsq_f32 v10, v10
    v_sub_f32 v128, v128, v8
    v_sub_f32 v129, v129, v8
    v_sub_f32 v130, v130, v8
    v_sub_f32 v131, v131, v8
    v_mul_f32 v128, v128, v68
    v_mul_f32 v129, v129, v69
    v_mul_f32 v130, v130, v70
    v_mul_f32 v131, v131, v71
    v_fma_f32 v128, v128, v10, v64
    v_fma_f32 v129, v129, v10, v65
    v_fma_f32 v130, v130, v10, v66
    v_fma_f32 v131, v131, v10, v67
    v_cvt_pk_bf16_f32 v28, v128, v129
    v_cvt_pk_bf16_f32 v30, v130, v131
    s_mov_b64 exec, s[28:29]
    s_cmp_eq_u32 s34, 1
    s_cbranch_scc1 L_st_25a
    buffer_store_dwordx4 v[28:31], v111, s[4:7], s72 offen sc1
    s_branch L_st_25b
L_st_25a:
    buffer_store_dwordx4 v[28:31], v111, s[4:7], s72 offen
L_st_25b:
    s_cmp_eq_u32 s34, 1
    s_cbranch_scc1 L_st_26a
    buffer_store_dwordx4 v[24:27], v111, s[4:7], s73 offen sc1
    s_branch L_st_26b
L_st_26a:
    buffer_store_dwordx4 v[24:27], v111, s[4:7], s73 offen
L_st_26b:
    s_branch L_exit
L_nrole:
    v_mov_b32 v12, 133440
L_nloc:
    ds_read_b32 v13, v12 offset:16
    s_waitcnt lgkmcnt(0)
    v_readfirstlane_b32 s22, v13
    s_nop 0
    s_cmp_ge_u32 s22, 30
    s_cbranch_scc1 L_nlocok
    s_sleep 64
    s_sub_u32 s66, s66, 1
    s_cmp_lg_u32 s66, 0
    s_cbranch_scc1 L_nloc
    s_branch L_exit
L_nlocok:
    v_and_b32 v58, 31, v1
    v_lshlrev_b32 v58, 3, v58
    s_lshl_b32 s22, s12, 8
    s_add_u32 s22, s22, 65536
    buffer_load_dwordx2 v[56:57], v58, s[4:7], s22 offen sc1
    s_waitcnt vmcnt(0)
    s_getreg_b32 s22, hwreg(HW_REG_XCC_ID)
    v_xor_b32 v56, s22, v56
    v_xor_b32 v57, s8, v57
    v_or_b32 v56, v56, v57
    v_cmp_ne_u32 vcc, 0, v56
    s_nop 0
    s_cmp_eq_u64 vcc, 0
    s_cselect_b32 s34, 1, 0
    v_mov_b32 v13, s34
    ds_write_b32 v12, v13 offset:28
    s_cmp_lg_u32 s15, 1
    s_cbranch_scc1 L_nbd
    v_mov_b32 v12, 133440
L_nkd:
    ds_read_b32 v13, v12 offset:32
    s_waitcnt lgkmcnt(0)
    v_readfirstlane_b32 s22, v13
    s_nop 0
    s_cmp_ge_u32 s22, 4
    s_cbranch_scc1 L_nkdok
    s_sleep 32
    s_sub_u32 s66, s66, 1
    s_cmp_lg_u32 s66, 0
    s_cbranch_scc1 L_nkd
    s_branch L_exit
L_nkdok:
    v_and_b32 v33, 1, v1
    v_lshlrev_b32 v33, 4, v33
    v_add_u32 v32, 133504, v33
    ds_read_b128 v[36:39], v32
    v_lshlrev_b32 v32, 3, v1
    v_add_u32 v32, 133888, v32
    s_mov_b32 s18, 16
    s_waitcnt lgkmcnt(0)
    v_max3_f32 v34, v36, v37, v38
    v_max_f32 v34, v34, v39
    v_mul_f32 v34, s61, v34
    v_mov_b32 v36, 0
L_nbl:
    ds_read2st64_b64 v[56:59], v32 offset0:0 offset1:1
    v_add_u32 v32, 1024, v32
    s_waitcnt lgkmcnt(0)
    v_lshlrev_b32 v38, 16, v56
    v_and_b32 v39, s60, v56
    v_fma_f32 v38, v38, s61, -v34
    v_fma_f32 v39, v39, s61, -v34
    v_exp_f32 v38, v38
    v_exp_f32 v39, v39
    v_add_f32 v36, v36, v38
    v_add_f32 v36, v36, v39
    v_lshlrev_b32 v38, 16, v57
    v_and_b32 v39, s60, v57
    v_fma_f32 v38, v38, s61, -v34
    v_fma_f32 v39, v39, s61, -v34
    v_exp_f32 v38, v38
    v_exp_f32 v39, v39
    v_add_f32 v36, v36, v38
    v_add_f32 v36, v36, v39
    v_lshlrev_b32 v38, 16, v58
    v_and_b32 v39, s60, v58
    v_fma_f32 v38, v38, s61, -v34
    v_fma_f32 v39, v39, s61, -v34
    v_exp_f32 v38, v38
    v_exp_f32 v39, v39
    v_add_f32 v36, v36, v38
    v_add_f32 v36, v36, v39
    v_lshlrev_b32 v38, 16, v59
    v_and_b32 v39, s60, v59
    v_fma_f32 v38, v38, s61, -v34
    v_fma_f32 v39, v39, s61, -v34
    v_exp_f32 v38, v38
    v_exp_f32 v39, v39
    v_add_f32 v36, v36, v38
    v_add_f32 v36, v36, v39
    s_sub_u32 s18, s18, 1
    s_cmp_lg_u32 s18, 0
    s_cbranch_scc1 L_nbl
    v_add_f32_dpp v36, v36, v36 quad_perm:[2,3,0,1] row_mask:0xf bank_mask:0xf
    s_nop 1
    v_add_f32_dpp v36, v36, v36 row_ror:4 row_mask:0xf bank_mask:0xf
    s_nop 1
    v_add_f32_dpp v36, v36, v36 row_ror:8 row_mask:0xf bank_mask:0xf
    v_mov_b32 v38, v36
    s_nop 1
    v_permlane16_swap_b32 v36, v38
    v_add_f32 v36, v36, v38
    v_mov_b32 v38, v36
    s_nop 1
    v_permlane32_swap_b32 v36, v38
    v_add_f32 v36, v36, v38
    v_mov_b32 v35, s8
    v_mov_b32 v37, s8
    s_lshl_b32 s20, s2, 7
    s_add_u32 s20, s20, 851968
    s_xor_b32 s21, s20, 1024
    s_mov_b64 exec, 3
    s_cmp_eq_u32 s34, 1
    s_cbranch_scc1 L_st_27a
    buffer_store_dwordx4 v[34:37], v33, s[4:7], s20 offen sc1
    s_branch L_st_27b
L_st_27a:
    buffer_store_dwordx4 v[34:37], v33, s[4:7], s20 offen
L_st_27b:
    v_mov_b32 v12, 133440
L_nxp:
    ds_read_b32 v13, v12 offset:16
    s_waitcnt lgkmcnt(0)
    v_readfirstlane_b32 s22, v13
    s_nop 0
    s_cmp_ge_u32 s22, 154
    s_cbranch_scc1 L_nxpok
    s_sleep 32
    s_sub_u32 s66, s66, 1
    s_cmp_lg_u32 s66, 0
    s_cbranch_scc1 L_nxp
    s_branch L_exit
L_nxpok:
L_nbalp:
    buffer_load_dwordx4 v[56:59], v33, s[4:7], s21 offen offset:0 sc1
    s_waitcnt vmcnt(0)
    v_bitop3_b32 v38, v57, v59, s8 bitop3:0x7e
    v_cmp_ne_u32 vcc, 0, v38
    s_nop 0
    s_cbranch_vccz L_nbalpok
    s_sleep 16
    s_sub_u32 s66, s66, 1
    s_cmp_lg_u32 s66, 0
    s_cbranch_scc1 L_nbalp
    s_branch L_exit
L_nbalpok:
    v_max_f32 v38, v34, v56
    v_sub_f32 v34, v34, v38
    v_sub_f32 v56, v56, v38
    v_exp_f32 v34, v34
    v_exp_f32 v56, v56
    v_mul_f32 v36, v36, v34
    v_fmac_f32 v36, v58, v56
    v_rcp_f32 v36, v36
    v_mov_b32 v35, 1
    v_mul_f32 v34, v34, v36
    v_lshrrev_b32 v33, 1, v33
    v_add_u32 v33, 133488, v33
    ds_write_b64 v33, v[34:35]
    s_waitcnt lgkmcnt(0)
    s_mov_b64 exec, -1
L_nbd:
    s_cmp_lg_u32 s15, 2
    s_cbranch_scc1 L_npd
    v_mov_b32 v32, 133440
    v_and_b32 v33, 7, v1
    v_mul_u32_u24 v33, 4352, v33
    v_mov_b32 v35, s8
    s_lshr_b32 s18, s2, 5
    s_mul_i32 s18, s18, 5
    s_add_u32 s18, s18, s2
    s_and_b32 s19, s18, 31
    s_lshr_b32 s18, s2, 5
    s_mul_i32 s18, s18, 4352
    s_cmp_eq_u32 s19, 0
    s_cselect_b32 s18, s18, 0x7ff00000
    v_mov_b32 v12, 133440
L_nc0u:
    ds_read_b32 v13, v12 offset:16
    s_waitcnt lgkmcnt(0)
    v_readfirstlane_b32 s22, v13
    s_nop 0
    s_cmp_ge_u32 s22, 46
    s_cbranch_scc1 L_nc0uok
    s_sleep 32
    s_sub_u32 s66, s66, 1
    s_cmp_lg_u32 s66, 0
    s_cbranch_scc1 L_nc0u
    s_branch L_exit
L_nc0uok:
    v_mov_b32 v12, 133440
L_nc0v:
    ds_read_b32 v13, v12 offset:16
    s_waitcnt lgkmcnt(0)
    v_readfirstlane_b32 s22, v13
    s_nop 0
    s_cmp_ge_u32 s22, 52
    s_cbranch_scc1 L_nc0vok
    s_sleep 2
    s_sub_u32 s66, s66, 1
    s_cmp_lg_u32 s66, 0
    s_cbranch_scc1 L_nc0v
    s_branch L_exit
L_nc0vok:
    s_memrealtime s[20:21]
    s_add_u32 s19, s18, 1572864
    s_waitcnt lgkmcnt(0)
    v_mov_b32 v34, s20
    s_mov_b64 exec, 1
    buffer_store_dwordx2 v[34:35], off, s[4:7], s19 sc1
    s_mov_b64 exec, -1
    v_mov_b32 v12, 133440
L_nc0w:
    ds_read_b32 v13, v12 offset:16
    s_waitcnt lgkmcnt(0)
    v_readfirstlane_b32 s22, v13
    s_nop 0
    s_cmp_ge_u32 s22, 64
    s_cbranch_scc1 L_nc0wok
    s_sleep 16
    s_sub_u32 s66, s66, 1
    s_cmp_lg_u32 s66, 0
    s_cbranch_scc1 L_nc0w
    s_branch L_exit
L_nc0wok:
    s_mov_b32 s19, 1572864
    buffer_load_dwordx2 v[36:37], v33, s[4:7], s19 offen sc1
    s_waitcnt vmcnt(0)
    ds_read_b32 v38, v32 offset:16
    v_sub_u32 v36, v34, v36
    v_mov_b32 v39, -336
    v_cmp_eq_u32 vcc, v35, v37
    s_nop 1
    v_cndmask_b32 v36, v39, v36, vcc
    v_cvt_f32_i32 v36, v36
    s_nop 1
    v_add_f32_dpp v36, v36, v36 quad_perm:[1,0,3,2] row_mask:0xf bank_mask:0xf
    s_nop 1
    v_add_f32_dpp v36, v36, v36 quad_perm:[2,3,0,1] row_mask:0xf bank_mask:0xf
    s_nop 1
    v_add_f32_dpp v36, v36, v36 row_half_mirror row_mask:0xf bank_mask:0xf
    s_nop 1
    v_add_f32_dpp v36, v36, v36 row_mirror row_mask:0xf bank_mask:0xf
    v_mov_b32 v39, v36
    s_nop 1
    v_permlane16_swap_b32 v36, v39
    v_add_f32 v36, v36, v39
    v_mov_b32 v39, v36
    s_nop 1
    v_permlane32_swap_b32 v36, v39
    v_add_f32 v36, v36, v39
    v_mov_b32 v39, 0x40800000
    v_fmac_f32 v39, 0x3b1467e2, v36
    v_max_f32 v39, 0, v39
    v_min_f32 v39, 0x42800000, v39
    v_cvt_u32_f32 v39, v39
    s_waitcnt lgkmcnt(0)
    v_add3_u32 v38, v38, v39, 40
    ds_write_b32 v32, v38 offset:12
    s_waitcnt lgkmcnt(0)
    v_mov_b32 v56, v34
    v_mov_b32 v57, v36
    v_mov_b32 v12, 133440
L_nc1u:
    ds_read_b32 v13, v12 offset:16
    s_waitcnt lgkmcnt(0)
    v_readfirstlane_b32 s22, v13
    s_nop 0
    s_cmp_ge_u32 s22, 106
    s_cbranch_scc1 L_nc1uok
    s_sleep 32
    s_sub_u32 s66, s66, 1
    s_cmp_lg_u32 s66, 0
    s_cbranch_scc1 L_nc1u
    s_branch L_exit
L_nc1uok:
    v_mov_b32 v12, 133440
L_nc1v:
    ds_read_b32 v13, v12 offset:16
    s_waitcnt lgkmcnt(0)
    v_readfirstlane_b32 s22, v13
    s_nop 0
    s_cmp_ge_u32 s22, 112
    s_cbranch_scc1 L_nc1vok
    s_sleep 2
    s_sub_u32 s66, s66, 1
    s_cmp_lg_u32 s66, 0
    s_cbranch_scc1 L_nc1v
    s_branch L_exit
L_nc1vok:
    s_memrealtime s[20:21]
    s_add_u32 s19, s18, 1572992
    s_waitcnt lgkmcnt(0)
    v_mov_b32 v34, s20
    s_mov_b64 exec, 1
    buffer_store_dwordx2 v[34:35], off, s[4:7], s19 sc1
    s_mov_b64 exec, -1
    v_mov_b32 v12, 133440
L_nc1w:
    ds_read_b32 v13, v12 offset:16
    s_waitcnt lgkmcnt(0)
    v_readfirstlane_b32 s22, v13
    s_nop 0
    s_cmp_ge_u32 s22, 124
    s_cbranch_scc1 L_nc1wok
    s_sleep 16
    s_sub_u32 s66, s66, 1
    s_cmp_lg_u32 s66, 0
    s_cbranch_scc1 L_nc1w
    s_branch L_exit
L_nc1wok:
    s_mov_b32 s19, 1572992
    buffer_load_dwordx2 v[36:37], v33, s[4:7], s19 offen sc1
    s_waitcnt vmcnt(0)
    ds_read_b32 v38, v32 offset:16
    v_sub_u32 v36, v34, v36
    v_mov_b32 v39, -336
    v_cmp_eq_u32 vcc, v35, v37
    s_nop 1
    v_cndmask_b32 v36, v39, v36, vcc
    v_cvt_f32_i32 v36, v36
    s_nop 1
    v_add_f32_dpp v36, v36, v36 quad_perm:[1,0,3,2] row_mask:0xf bank_mask:0xf
    s_nop 1
    v_add_f32_dpp v36, v36, v36 quad_perm:[2,3,0,1] row_mask:0xf bank_mask:0xf
    s_nop 1
    v_add_f32_dpp v36, v36, v36 row_half_mirror row_mask:0xf bank_mask:0xf
    s_nop 1
    v_add_f32_dpp v36, v36, v36 row_mirror row_mask:0xf bank_mask:0xf
    v_mov_b32 v39, v36
    s_nop 1
    v_permlane16_swap_b32 v36, v39
    v_add_f32 v36, v36, v39
    v_mov_b32 v39, v36
    s_nop 1
    v_permlane32_swap_b32 v36, v39
    v_add_f32 v36, v36, v39
    v_mov_b32 v39, 0x40800000
    v_fmac_f32 v39, 0x3b1467e2, v36
    v_max_f32 v39, 0, v39
    v_min_f32 v39, 0x42800000, v39
    v_cvt_u32_f32 v39, v39
    s_waitcnt lgkmcnt(0)
    v_add3_u32 v38, v38, v39, 40
    ds_write_b32 v32, v38 offset:12
    s_waitcnt lgkmcnt(0)
    v_mov_b32 v56, v34
    v_mov_b32 v57, v36
    v_mov_b32 v12, 133440
L_nc2u:
    ds_read_b32 v13, v12 offset:16
    s_waitcnt lgkmcnt(0)
    v_readfirstlane_b32 s22, v13
    s_nop 0
    s_cmp_ge_u32 s22, 151
    s_cbranch_scc1 L_nc2uok
    s_sleep 32
    s_sub_u32 s66, s66, 1
    s_cmp_lg_u32 s66, 0
    s_cbranch_scc1 L_nc2u
    s_branch L_exit
L_nc2uok:
    v_mov_b32 v12, 133440
L_nc2v:
    ds_read_b32 v13, v12 offset:16
    s_waitcnt lgkmcnt(0)
    v_readfirstlane_b32 s22, v13
    s_nop 0
    s_cmp_ge_u32 s22, 157
    s_cbranch_scc1 L_nc2vok
    s_sleep 2
    s_sub_u32 s66, s66, 1
    s_cmp_lg_u32 s66, 0
    s_cbranch_scc1 L_nc2v
    s_branch L_exit
L_nc2vok:
    s_memrealtime s[20:21]
    s_add_u32 s19, s18, 1573120
    s_waitcnt lgkmcnt(0)
    v_mov_b32 v34, s20
    s_mov_b64 exec, 1
    buffer_store_dwordx2 v[34:35], off, s[4:7], s19 sc1
    s_mov_b64 exec, -1
    v_mov_b32 v12, 133440
L_nc2w:
    ds_read_b32 v13, v12 offset:16
    s_waitcnt lgkmcnt(0)
    v_readfirstlane_b32 s22, v13
    s_nop 0
    s_cmp_ge_u32 s22, 169
    s_cbranch_scc1 L_nc2wok
    s_sleep 16
    s_sub_u32 s66, s66, 1
    s_cmp_lg_u32 s66, 0
    s_cbranch_scc1 L_nc2w
    s_branch L_exit
L_nc2wok:
    s_mov_b32 s19, 1573120
    buffer_load_dwordx2 v[36:37], v33, s[4:7], s19 offen sc1
    s_waitcnt vmcnt(0)
    ds_read_b32 v38, v32 offset:16
    v_sub_u32 v36, v34, v36
    v_mov_b32 v39, -336
    v_cmp_eq_u32 vcc, v35, v37
    s_nop 1
    v_cndmask_b32 v36, v39, v36, vcc
    v_cvt_f32_i32 v36, v36
    s_nop 1
    v_add_f32_dpp v36, v36, v36 quad_perm:[1,0,3,2] row_mask:0xf bank_mask:0xf
    s_nop 1
    v_add_f32_dpp v36, v36, v36 quad_perm:[2,3,0,1] row_mask:0xf bank_mask:0xf
    s_nop 1
    v_add_f32_dpp v36, v36, v36 row_half_mirror row_mask:0xf bank_mask:0xf
    s_nop 1
    v_add_f32_dpp v36, v36, v36 row_mirror row_mask:0xf bank_mask:0xf
    v_mov_b32 v39, v36
    s_nop 1
    v_permlane16_swap_b32 v36, v39
    v_add_f32 v36, v36, v39
    v_mov_b32 v39, v36
    s_nop 1
    v_permlane32_swap_b32 v36, v39
    v_add_f32 v36, v36, v39
    v_mov_b32 v39, 0x40800000
    v_fmac_f32 v39, 0x3b1467e2, v36
    v_max_f32 v39, 0, v39
    v_min_f32 v39, 0x42800000, v39
    v_cvt_u32_f32 v39, v39
    s_waitcnt lgkmcnt(0)
    v_add3_u32 v38, v38, v39, 40
    ds_write_b32 v32, v38 offset:12
    s_waitcnt lgkmcnt(0)
    v_mov_b32 v56, v34
    v_mov_b32 v57, v36
    v_mov_b32 v12, 133440
L_nc3u:
    ds_read_b32 v13, v12 offset:16
    s_waitcnt lgkmcnt(0)
    v_readfirstlane_b32 s22, v13
    s_nop 0
    s_cmp_ge_u32 s22, 178
    s_cbranch_scc1 L_nc3uok
    s_sleep 32
    s_sub_u32 s66, s66, 1
    s_cmp_lg_u32 s66, 0
    s_cbranch_scc1 L_nc3u
    s_branch L_exit
L_nc3uok:
    v_mov_b32 v12, 133440
L_nc3v:
    ds_read_b32 v13, v12 offset:16
    s_waitcnt lgkmcnt(0)
    v_readfirstlane_b32 s22, v13
    s_nop 0
    s_cmp_ge_u32 s22, 184
    s_cbranch_scc1 L_nc3vok
    s_sleep 2
    s_sub_u32 s66, s66, 1
    s_cmp_lg_u32 s66, 0
    s_cbranch_scc1 L_nc3v
    s_branch L_exit
L_nc3vok:
    s_memrealtime s[20:21]
    s_add_u32 s19, s18, 1573248
    s_waitcnt lgkmcnt(0)
    v_mov_b32 v34, s20
    s_mov_b64 exec, 1
    buffer_store_dwordx2 v[34:35], off, s[4:7], s19 sc1
    s_mov_b64 exec, -1
    v_mov_b32 v12, 133440
L_nc3w:
    ds_read_b32 v13, v12 offset:16
    s_waitcnt lgkmcnt(0)
    v_readfirstlane_b32 s22, v13
    s_nop 0
    s_cmp_ge_u32 s22, 196
    s_cbranch_scc1 L_nc3wok
    s_sleep 16
    s_sub_u32 s66, s66, 1
    s_cmp_lg_u32 s66, 0
    s_cbranch_scc1 L_nc3w
    s_branch L_exit
L_nc3wok:
    s_mov_b32 s19, 1573248
    buffer_load_dwordx2 v[36:37], v33, s[4:7], s19 offen sc1
    s_waitcnt vmcnt(0)
    ds_read_b32 v38, v32 offset:16
    v_sub_u32 v36, v34, v36
    v_mov_b32 v39, -336
    v_cmp_eq_u32 vcc, v35, v37
    s_nop 1
    v_cndmask_b32 v36, v39, v36, vcc
    v_cvt_f32_i32 v36, v36
    s_nop 1
    v_add_f32_dpp v36, v36, v36 quad_perm:[1,0,3,2] row_mask:0xf bank_mask:0xf
    s_nop 1
    v_add_f32_dpp v36, v36, v36 quad_perm:[2,3,0,1] row_mask:0xf bank_mask:0xf
    s_nop 1
    v_add_f32_dpp v36, v36, v36 row_half_mirror row_mask:0xf bank_mask:0xf
    s_nop 1
    v_add_f32_dpp v36, v36, v36 row_mirror row_mask:0xf bank_mask:0xf
    v_mov_b32 v39, v36
    s_nop 1
    v_permlane16_swap_b32 v36, v39
    v_add_f32 v36, v36, v39
    v_mov_b32 v39, v36
    s_nop 1
    v_permlane32_swap_b32 v36, v39
    v_add_f32 v36, v36, v39
    v_sub_u32 v56, v34, v56
    v_cvt_f32_i32 v56, v56
    v_sub_f32 v57, v57, v36
    v_fmac_f32 v56, 0x3c800000, v57
    v_rcp_f32 v56, v56
    v_mul_f32 v36, 0x3c800000, v36
    v_mul_f32 v56, 0x41d80000, v56
    s_memrealtime s[20:21]
    ds_read_b32 v38, v32 offset:16
    s_waitcnt lgkmcnt(0)
    v_sub_u32 v39, s20, v34
    v_cvt_f32_i32 v39, v39
    v_add_f32 v39, v39, v36
    v_cvt_f32_u32 v58, v38
    v_subrev_f32 v58, 0x43390000, v58
    v_fma_f32 v39, v39, v56, -v58
    v_mul_f32 v39, 0x40800000, v39
    v_max_f32 v39, 0, v39
    v_min_f32 v39, 0x42800000, v39
    v_cvt_u32_f32 v39, v39
    v_add3_u32 v38, v38, v39, 40
    ds_write_b32 v32, v38 offset:12
    s_waitcnt lgkmcnt(0)
L_npd:
    s_mov_b32 s52, s32
    s_mov_b32 s53, s33
    s_mov_b32 s54, 5308416
    s_mov_b32 s55, 0x20000
    s_bfm_b32 s18, s13, 0
    s_and_b32 s18, s18, 0xaa80000
    s_bcnt1_i32_b32 s18, s18
    s_lshl_b32 s18, s18, 2
    s_add_u32 s18, s18, s15
    v_min_u32 v8, 39, v1
    v_lshlrev_b32 v8, 7, v8
    s_mul_i32 s19, s12, 663552
    s_add_u32 s19, s19, 4096
    s_mul_i32 s20, s18, 9216
    s_add_u32 s19, s19, s20
    s_mov_b32 s48, s30
    s_mov_b32 s49, s31
    s_mov_b32 s50, 5308416
    s_mov_b32 s51, 0x20000
    v_min_u32 v9, 62, v1
    v_mul_u32_u24 v10, 7282, v9
    v_lshrrev_b32 v10, 16, v10
    v_mul_u32_u24 v10, 8064, v10
    v_lshl_add_u32 v9, v9, 7, v10
    s_mul_i32 s21, s15, 160
    s_add_u32 s21, s21, 160
    s_cmp_eq_u32 s15, 2
    s_cselect_b32 s21, 448, s21
    s_cmp_eq_u32 s15, 3
    s_cselect_b32 s21, 576, s21
    s_lshr_b32 s20, s18, 2
    s_mul_i32 s20, s20, 7
    s_add_u32 s21, s21, s20
    s_sub_u32 s21, s21, 35
    s_mul_i32 s21, s21, 9216
    s_mul_i32 s20, s12, 1152
    s_add_u32 s21, s21, s20
    v_mov_b32 v12, 133440
L_npf:
    ds_read_b32 v13, v12 offset:20
    s_waitcnt lgkmcnt(0)
    v_readfirstlane_b32 s22, v13
    s_nop 0
    s_cmp_ge_u32 s22, 1
    s_cbranch_scc1 L_npfok
    s_sleep 2
    s_sub_u32 s66, s66, 1
    s_cmp_lg_u32 s66, 0
    s_cbranch_scc1 L_npf
    s_branch L_exit
L_npfok:
    buffer_load_dword v24, v9, s[48:51], s21 offen
    s_add_u32 s21, s21, 322560
    buffer_load_dword v16, v8, s[52:55], s19 offen
    s_add_u32 s19, s19, 184320
    buffer_load_dword v17, v8, s[52:55], s19 offen
    s_add_u32 s19, s19, 184320
    buffer_load_dword v18, v8, s[52:55], s19 offen
    s_add_u32 s19, s19, 184320
    s_cmp_ge_u32 s18, 12
    s_cbranch_scc1 L_exit
    buffer_load_dword v19, v8, s[52:55], s19 offen
    s_add_u32 s19, s19, 184320
L_exit:
L_end:
    s_endpgm
L_codeend:
.section .rodata,"a"
.p2align 6
.amdhsa_kernel adaLN_cond__gqa_block_cached__glu_gated_geglu__decode_kernel
  .amdhsa_next_free_vgpr 256
  .amdhsa_next_free_sgpr 102
  .amdhsa_accum_offset 256
  .amdhsa_group_segment_fixed_size 0
  .amdhsa_kernarg_size 112
  .amdhsa_user_sgpr_count 2
  .amdhsa_user_sgpr_kernarg_segment_ptr 1
  .amdhsa_system_sgpr_workgroup_id_x 1
.end_amdhsa_kernel
```
